```python
import torch

def _softmax(x, axis=-1):
    return torch.softmax(x, dim=axis)
def _gelu(x):
    return torch.nn.functional.gelu(x, approximate="tanh")
def _silu(x):
    return torch.nn.functional.silu(x)
def _sigmoid(x):
    return torch.sigmoid(x)
def _layernorm(x, axis=-1, eps=1e-5):
    m = x.mean(dim=axis, keepdim=True)
    v = x.var(dim=axis, keepdim=True, unbiased=False)
    return (x - m) / torch.sqrt(v + eps)
def _scatter_add(tgt, idx, src, axis=0):
    return tgt.clone().index_add_(axis, idx, src)
def _segment_sum(src, seg, n):
    out = torch.zeros((n,) + src.shape[1:], dtype=src.dtype)
    return out.index_add_(0, seg, src)
def _pad(x, pw):
    flat = tuple(v for pair in reversed(pw) for v in pair)
    return torch.nn.functional.pad(x, flat)

kernel_name = 'gather_scatter__hybrid_graph_tf_exphormer__graph'

def setup_inputs():

    _w = (lambda a: (lambda t: t.to(torch.bfloat16) if t.is_floating_point() else t)(torch.as_tensor(a)))
    N, deg, D = 10000, 16, 256
    E = N * deg
    exp_deg = 4
    Ee = N * exp_deg
    src = (lambda lo, hi, *s: torch.randint(lo, hi, s))(0, N, E).to(torch.int64)
    dst = (lambda lo, hi, *s: torch.randint(lo, hi, s))(0, N, E).to(torch.int64)
    esrc = (lambda lo, hi, *s: torch.randint(lo, hi, s))(0, N, Ee).to(torch.int64)
    edst = torch.repeat_interleave(torch.arange(N), exp_deg).to(torch.int64)
    deg_cnt = torch.bincount(dst, minlength=N).to(float) + 1.0
    return {
        "x": _w((lambda *s: torch.randn(*s, dtype=torch.bfloat16) * 0.05)(N, D)),
        "src": _w(src),
        "dst": _w(dst),
        "esrc": _w(esrc),
        "edst": _w(edst),
        "deg_inv_sqrt": _w(1.0 / (lambda _x: torch.sqrt(torch.as_tensor(_x)))(deg_cnt)),
        "w_l": _w((lambda *s: torch.randn(*s, dtype=torch.bfloat16) * 0.05)(D, D)),
        "wq": _w((lambda *s: torch.randn(*s, dtype=torch.bfloat16) * 0.05)(D, D)),
        "wk": _w((lambda *s: torch.randn(*s, dtype=torch.bfloat16) * 0.05)(D, D)),
        "wv": _w((lambda *s: torch.randn(*s, dtype=torch.bfloat16) * 0.05)(D, D)),
    }

def reference(x, src, dst, esrc, edst, deg_inv_sqrt, w_l, wq, wk, wv):
    N, D = x.shape
    h = x @ w_l
    msg = h[src] * deg_inv_sqrt[src, None] * deg_inv_sqrt[dst, None]
    h_local = _segment_sum(msg, dst, N)
    q = x @ wq
    k = x @ wk
    v = x @ wv
    e = (q[edst] * k[esrc]).sum(-1) * (D ** -0.5)
    exp_e = torch.exp(e)
    denom = _segment_sum(exp_e[:, None], edst, N)[:, 0] + 1e-9
    alpha = exp_e / denom[edst]
    h_attn = _segment_sum(alpha[:, None] * v[esrc], edst, N)
    return h_local + h_attn
```

```asm
; @launch grid=(256,1,1) block=(512,1,1) lds=163840
.amdgcn_target "amdgcn-amd-amdhsa--gfx950"
.text
.globl gather_scatter__hybrid_graph_tf_exphormer__graph_kernel
.p2align 8
.type gather_scatter__hybrid_graph_tf_exphormer__graph_kernel,@function
gather_scatter__hybrid_graph_tf_exphormer__graph_kernel:
    s_cmp_ge_u32 s2, 256
    s_cbranch_scc1 L_end
    s_load_dwordx16 s[4:19], s[0:1], 0
    s_load_dwordx8 s[20:27], s[0:1], 64
    s_load_dwordx2 s[28:29], s[0:1], 96
    s_getpc_b64 s[30:31]
L_pc:
    v_and_b32 v1, 63, v0
    v_lshrrev_b32 v2, 6, v0
    v_and_b32 v3, 7, v0
    v_readfirstlane_b32 s3, v2
    s_lshr_b32 s52, s2, 3
    s_and_b32 s52, s52, 31
    s_mul_i32 s52, s52, 1024
    v_lshl_add_u32 v3, v3, 7, s52
    v_min_u32 v3, L_code_end-L_pc-4, v3
    v_mov_b64 v[12:13], 0
    v_mov_b64 v[14:15], 0
    v_lshlrev_b32 v16, 4, v0
    global_load_dword v59, v3, s[30:31]
    v_and_b32 v17, 0xfff, v16
    ds_write_b128 v16, v[12:15] offset:45056
    ds_write_b128 v16, v[12:15] offset:53248
    ds_write_b128 v17, v[12:15] offset:40960
    v_mov_b32 v0, 1
    s_and_b32 s51, s3, 3
    v_and_b32 v30, 15, v1
    v_lshrrev_b32 v29, 4, v1
    v_lshrrev_b32 v31, 5, v1
    v_and_b32 v3, 31, v1
    v_lshlrev_b32 v3, 4, v3
    v_xor_b32 v19, v29, v30
    v_lshlrev_b32 v19, 4, v19
    v_lshl_or_b32 v8, v30, 9, v19
    v_xor_b32 v9, 64, v8
    v_xor_b32 v10, 0x80, v8
    v_xor_b32 v11, 0xc0, v8
    s_lshl_b32 s52, s51, 7
    v_lshlrev_b32 v2, 12, v29
    v_lshl_add_u32 v2, v30, 2, v2
    v_add_u32 v2, s52, v2
    s_mul_i32 s53, s2, 160
    s_mul_i32 s54, s51, 40
    s_add_u32 s53, s53, s54
    v_lshl_add_u32 v20, v30, 1, v31
    v_add_u32 v21, s53, v20
    v_min_u32 v34, 39999, v21
    v_lshlrev_b32 v34, 2, v34
    v_add_u32 v35, 32, v21
    v_min_u32 v35, 39999, v35
    v_lshlrev_b32 v35, 2, v35
    s_lshl_b32 s54, s51, 3
    v_add_u32 v20, s54, v20
    v_and_b32 v20, 15, v20
    v_lshlrev_b32 v33, 4, v20
    v_lshlrev_b32 v32, 4, v31
    v_xor_b32 v32, v32, v3
    v_lshl_or_b32 v32, v31, 9, v32
    s_lshl_b32 s54, s51, 5
    v_xor_b32 v26, s54, v32
    s_mul_i32 s54, s2, 20480
    v_add_u32 v6, s54, v26
    v_xor_b32 v7, 0x80, v6
    s_mov_b32 s48, 0x05040100
    s_mov_b32 s49, 0x07060302
    s_mov_b32 s50, 0x03020302
    s_mov_b32 s34, 5120000
    s_mov_b32 s35, 0x20000
    s_mov_b32 s39, 0x20000
    s_mov_b32 s47, 0x20000
    s_cmp_ge_u32 s3, 4
    s_cbranch_scc1 L_B
    s_mov_b32 s38, 131072
    s_waitcnt lgkmcnt(0)
    s_mov_b32 s40, s22
    s_mov_b32 s41, s23
    s_mov_b32 s32, s4
    s_mov_b32 s33, s5
    s_barrier
    s_and_b32 s52, s2, 15
    s_lshl_b32 s52, s52, 13
    s_lshl_b32 s55, s51, 11
    s_add_u32 s52, s52, s55
    s_lshr_b32 s53, s2, 6
    s_lshl_b32 s53, s53, 15
    s_bfe_u32 s54, s2, 0x20004
    s_lshl_b32 s54, s54, 9
    s_add_u32 s53, s53, s54
    s_lshl_b32 s54, s51, 13
    s_add_u32 s53, s53, s54
    s_lshl_b32 s54, s51, 6
    v_xor_b32 v44, s54, v32
    v_lshlrev_b32 v45, 9, v31
    v_add3_u32 v46, v44, v45, v45
    v_add_u32 v46, v46, v45
    v_add_u32 v45, s52, v44
    v_add_u32 v46, s53, v46
    v_xor_b32 v47, 32, v45
    v_xor_b32 v48, 32, v46
    v_add_u32 v47, 0x400, v47
    v_add_u32 v48, 0x1000, v48
    s_add_u32 m0, s55, 20480
    s_bfe_u32 s52, s2, 0x30002
    s_lshl_b32 s52, s52, 14
    global_load_lds_dwordx4 v45, s[18:19]
    s_add_u32 m0, m0, 1024
    s_bfe_u32 s53, s2, 0x20005
    global_load_lds_dwordx4 v47, s[18:19]
    s_add_u32 m0, m0, 7168
    s_lshl_b32 s53, s53, 7
    global_load_lds_dwordx4 v46, s[20:21]
    s_add_u32 m0, m0, 1024
    s_add_u32 s52, s52, s53
    global_load_lds_dwordx4 v48, s[20:21]
    s_lshl_b32 s53, s51, 12
    s_add_u32 s52, s52, s53
    v_lshrrev_b32 v44, 3, v1
    v_lshlrev_b32 v44, 9, v44
    v_and_b32 v45, 7, v1
    v_lshl_or_b32 v44, v45, 4, v44
    v_add_u32 v44, s52, v44
    s_lshl_b32 s53, s51, 10
    s_add_u32 m0, s53, 36864
    s_nop 0
    global_load_lds_dwordx4 v44, s[16:17]
    global_load_dword v4, v34, s[10:11]
    global_load_dword v5, v35, s[10:11]
    s_add_u32 s36, s28, 69632
    s_addc_u32 s37, s29, 0
    s_mul_i32 s10, s51, 20480
    s_add_u32 s10, s10, 81920
    s_cmp_ge_u32 s2, 250
    s_cbranch_scc1 L_Ahelp
    s_lshr_b32 s52, s2, 3
    s_lshl_b32 s52, s52, 12
    v_and_b32 v36, 31, v1
    v_lshl_add_u32 v36, v36, 7, s52
    s_cmp_eq_u32 s3, 0
    s_cselect_b64 exec, -1, 0
    global_load_dword v36, v36, s[22:23]
    s_mov_b64 exec, -1
    global_load_dword v128, v2, s[40:41] offset:0
    global_load_dword v136, v2, s[40:41] offset:64
    global_load_dword v132, v2, s[40:41] offset:512
    global_load_dword v140, v2, s[40:41] offset:576
    global_load_dword v129, v2, s[40:41] offset:1024
    global_load_dword v137, v2, s[40:41] offset:1088
    global_load_dword v133, v2, s[40:41] offset:1536
    global_load_dword v141, v2, s[40:41] offset:1600
    global_load_dword v130, v2, s[40:41] offset:2048
    global_load_dword v138, v2, s[40:41] offset:2112
    global_load_dword v134, v2, s[40:41] offset:2560
    global_load_dword v142, v2, s[40:41] offset:2624
    global_load_dword v131, v2, s[40:41] offset:3072
    global_load_dword v139, v2, s[40:41] offset:3136
    global_load_dword v135, v2, s[40:41] offset:3584
    global_load_dword v143, v2, s[40:41] offset:3648
    s_add_u32 s40, s40, 16384
    s_addc_u32 s41, s41, 0
    global_load_dword v144, v2, s[40:41] offset:0
    global_load_dword v152, v2, s[40:41] offset:64
    global_load_dword v148, v2, s[40:41] offset:512
    global_load_dword v156, v2, s[40:41] offset:576
    global_load_dword v145, v2, s[40:41] offset:1024
    global_load_dword v153, v2, s[40:41] offset:1088
    global_load_dword v149, v2, s[40:41] offset:1536
    global_load_dword v157, v2, s[40:41] offset:1600
    global_load_dword v146, v2, s[40:41] offset:2048
    global_load_dword v154, v2, s[40:41] offset:2112
    global_load_dword v150, v2, s[40:41] offset:2560
    global_load_dword v158, v2, s[40:41] offset:2624
    global_load_dword v147, v2, s[40:41] offset:3072
    global_load_dword v155, v2, s[40:41] offset:3136
    global_load_dword v151, v2, s[40:41] offset:3584
    global_load_dword v159, v2, s[40:41] offset:3648
    s_waitcnt vmcnt(33)
    s_mov_b64 exec, 1
    ds_add_u32 v1, v0 offset:43032
    s_mov_b64 exec, -1
    v_lshl_or_b32 v4, v4, 9, v33
    v_lshl_or_b32 v5, v5, 9, v33
    s_add_u32 s40, s40, 16384
    s_addc_u32 s41, s41, 0
    global_load_dword v160, v2, s[40:41] offset:0
    global_load_dword v168, v2, s[40:41] offset:64
    global_load_dword v164, v2, s[40:41] offset:512
    global_load_dword v172, v2, s[40:41] offset:576
    global_load_dword v161, v2, s[40:41] offset:1024
    global_load_dword v169, v2, s[40:41] offset:1088
    global_load_dword v165, v2, s[40:41] offset:1536
    global_load_dword v173, v2, s[40:41] offset:1600
    global_load_dword v162, v2, s[40:41] offset:2048
    global_load_dword v170, v2, s[40:41] offset:2112
    global_load_dword v166, v2, s[40:41] offset:2560
    global_load_dword v174, v2, s[40:41] offset:2624
    global_load_dword v163, v2, s[40:41] offset:3072
    global_load_dword v171, v2, s[40:41] offset:3136
    global_load_dword v167, v2, s[40:41] offset:3584
    global_load_dword v175, v2, s[40:41] offset:3648
    s_waitcnt vmcnt(32)
    v_perm_b32 v124, v132, v128, s48
    v_perm_b32 v132, v132, v128, s49
    v_perm_b32 v125, v133, v129, s48
    v_perm_b32 v133, v133, v129, s49
    v_perm_b32 v126, v134, v130, s48
    v_perm_b32 v134, v134, v130, s49
    v_perm_b32 v127, v135, v131, s48
    v_perm_b32 v135, v135, v131, s49
    v_perm_b32 v128, v140, v136, s48
    v_perm_b32 v140, v140, v136, s49
    v_perm_b32 v129, v141, v137, s48
    v_perm_b32 v141, v141, v137, s49
    v_perm_b32 v130, v142, v138, s48
    v_perm_b32 v142, v142, v138, s49
    v_perm_b32 v131, v143, v139, s48
    v_perm_b32 v143, v143, v139, s49
    s_add_u32 s40, s40, 16384
    s_addc_u32 s41, s41, 0
    global_load_dword v176, v2, s[40:41] offset:0
    global_load_dword v184, v2, s[40:41] offset:64
    global_load_dword v180, v2, s[40:41] offset:512
    global_load_dword v188, v2, s[40:41] offset:576
    global_load_dword v177, v2, s[40:41] offset:1024
    global_load_dword v185, v2, s[40:41] offset:1088
    global_load_dword v181, v2, s[40:41] offset:1536
    global_load_dword v189, v2, s[40:41] offset:1600
    global_load_dword v178, v2, s[40:41] offset:2048
    global_load_dword v186, v2, s[40:41] offset:2112
    global_load_dword v182, v2, s[40:41] offset:2560
    global_load_dword v190, v2, s[40:41] offset:2624
    global_load_dword v179, v2, s[40:41] offset:3072
    global_load_dword v187, v2, s[40:41] offset:3136
    global_load_dword v183, v2, s[40:41] offset:3584
    global_load_dword v191, v2, s[40:41] offset:3648
    s_waitcnt vmcnt(32)
    v_perm_b32 v136, v148, v144, s48
    v_perm_b32 v148, v148, v144, s49
    v_perm_b32 v137, v149, v145, s48
    v_perm_b32 v149, v149, v145, s49
    v_perm_b32 v138, v150, v146, s48
    v_perm_b32 v150, v150, v146, s49
    v_perm_b32 v139, v151, v147, s48
    v_perm_b32 v151, v151, v147, s49
    v_perm_b32 v144, v156, v152, s48
    v_perm_b32 v156, v156, v152, s49
    v_perm_b32 v145, v157, v153, s48
    v_perm_b32 v157, v157, v153, s49
    v_perm_b32 v146, v158, v154, s48
    v_perm_b32 v158, v158, v154, s49
    v_perm_b32 v147, v159, v155, s48
    v_perm_b32 v159, v159, v155, s49
    s_add_u32 s40, s40, 16384
    s_addc_u32 s41, s41, 0
    global_load_dword v192, v2, s[40:41] offset:0
    global_load_dword v200, v2, s[40:41] offset:64
    global_load_dword v196, v2, s[40:41] offset:512
    global_load_dword v204, v2, s[40:41] offset:576
    global_load_dword v193, v2, s[40:41] offset:1024
    global_load_dword v201, v2, s[40:41] offset:1088
    global_load_dword v197, v2, s[40:41] offset:1536
    global_load_dword v205, v2, s[40:41] offset:1600
    global_load_dword v194, v2, s[40:41] offset:2048
    global_load_dword v202, v2, s[40:41] offset:2112
    global_load_dword v198, v2, s[40:41] offset:2560
    global_load_dword v206, v2, s[40:41] offset:2624
    global_load_dword v195, v2, s[40:41] offset:3072
    global_load_dword v203, v2, s[40:41] offset:3136
    global_load_dword v199, v2, s[40:41] offset:3584
    global_load_dword v207, v2, s[40:41] offset:3648
    s_lshl_b32 m0, s51, 10
    s_nop 0
    buffer_load_dwordx4 v6, s[32:35], m0 offen  lds
    s_add_u32 m0, m0, 4096
    s_nop 0
    buffer_load_dwordx4 v7, s[32:35], m0 offen  lds
    s_add_u32 m0, m0, 4096
    s_nop 0
    buffer_load_dwordx4 v6, s[32:35], m0 offen  lds
    s_add_u32 m0, m0, 4096
    s_nop 0
    buffer_load_dwordx4 v7, s[32:35], m0 offen  lds
    s_add_u32 m0, m0, 4096
    s_nop 0
    buffer_load_dwordx4 v6, s[32:35], m0 offen  lds
    s_waitcnt vmcnt(37)
    v_perm_b32 v152, v164, v160, s48
    v_perm_b32 v164, v164, v160, s49
    v_perm_b32 v153, v165, v161, s48
    v_perm_b32 v165, v165, v161, s49
    v_perm_b32 v154, v166, v162, s48
    v_perm_b32 v166, v166, v162, s49
    v_perm_b32 v155, v167, v163, s48
    v_perm_b32 v167, v167, v163, s49
    v_perm_b32 v160, v172, v168, s48
    v_perm_b32 v172, v172, v168, s49
    v_perm_b32 v161, v173, v169, s48
    v_perm_b32 v173, v173, v169, s49
    v_perm_b32 v162, v174, v170, s48
    v_perm_b32 v174, v174, v170, s49
    v_perm_b32 v163, v175, v171, s48
    v_perm_b32 v175, v175, v171, s49
    s_waitcnt vmcnt(21)
    v_perm_b32 v168, v180, v176, s48
    v_perm_b32 v180, v180, v176, s49
    v_perm_b32 v169, v181, v177, s48
    v_perm_b32 v181, v181, v177, s49
    v_perm_b32 v170, v182, v178, s48
    v_perm_b32 v182, v182, v178, s49
    v_perm_b32 v171, v183, v179, s48
    v_perm_b32 v183, v183, v179, s49
    v_perm_b32 v176, v188, v184, s48
    v_perm_b32 v188, v188, v184, s49
    v_perm_b32 v177, v189, v185, s48
    v_perm_b32 v189, v189, v185, s49
    v_perm_b32 v178, v190, v186, s48
    v_perm_b32 v190, v190, v186, s49
    v_perm_b32 v179, v191, v187, s48
    v_perm_b32 v191, v191, v187, s49
    s_add_u32 s40, s40, 16384
    s_addc_u32 s41, s41, 0
    global_load_dword v208, v2, s[40:41] offset:0
    global_load_dword v216, v2, s[40:41] offset:64
    global_load_dword v212, v2, s[40:41] offset:512
    global_load_dword v220, v2, s[40:41] offset:576
    global_load_dword v209, v2, s[40:41] offset:1024
    global_load_dword v217, v2, s[40:41] offset:1088
    global_load_dword v213, v2, s[40:41] offset:1536
    global_load_dword v221, v2, s[40:41] offset:1600
    global_load_dword v210, v2, s[40:41] offset:2048
    global_load_dword v218, v2, s[40:41] offset:2112
    global_load_dword v214, v2, s[40:41] offset:2560
    global_load_dword v222, v2, s[40:41] offset:2624
    global_load_dword v211, v2, s[40:41] offset:3072
    global_load_dword v219, v2, s[40:41] offset:3136
    global_load_dword v215, v2, s[40:41] offset:3584
    global_load_dword v223, v2, s[40:41] offset:3648
    s_waitcnt vmcnt(21)
    v_perm_b32 v184, v196, v192, s48
    v_perm_b32 v196, v196, v192, s49
    v_perm_b32 v185, v197, v193, s48
    v_perm_b32 v197, v197, v193, s49
    v_perm_b32 v186, v198, v194, s48
    v_perm_b32 v198, v198, v194, s49
    v_perm_b32 v187, v199, v195, s48
    v_perm_b32 v199, v199, v195, s49
    v_perm_b32 v192, v204, v200, s48
    v_perm_b32 v204, v204, v200, s49
    v_perm_b32 v193, v205, v201, s48
    v_perm_b32 v205, v205, v201, s49
    v_perm_b32 v194, v206, v202, s48
    v_perm_b32 v206, v206, v202, s49
    v_perm_b32 v195, v207, v203, s48
    v_perm_b32 v207, v207, v203, s49
    s_add_u32 s40, s40, 16384
    s_addc_u32 s41, s41, 0
    global_load_dword v224, v2, s[40:41] offset:0
    global_load_dword v232, v2, s[40:41] offset:64
    global_load_dword v228, v2, s[40:41] offset:512
    global_load_dword v236, v2, s[40:41] offset:576
    global_load_dword v225, v2, s[40:41] offset:1024
    global_load_dword v233, v2, s[40:41] offset:1088
    global_load_dword v229, v2, s[40:41] offset:1536
    global_load_dword v237, v2, s[40:41] offset:1600
    global_load_dword v226, v2, s[40:41] offset:2048
    global_load_dword v234, v2, s[40:41] offset:2112
    global_load_dword v230, v2, s[40:41] offset:2560
    global_load_dword v238, v2, s[40:41] offset:2624
    global_load_dword v227, v2, s[40:41] offset:3072
    global_load_dword v235, v2, s[40:41] offset:3136
    global_load_dword v231, v2, s[40:41] offset:3584
    global_load_dword v239, v2, s[40:41] offset:3648
    s_waitcnt vmcnt(16)
    s_mov_b64 exec, 1
    ds_add_u32 v1, v0 offset:43036
    s_mov_b64 exec, -1
    v_perm_b32 v200, v212, v208, s48
    v_perm_b32 v212, v212, v208, s49
    v_perm_b32 v201, v213, v209, s48
    v_perm_b32 v213, v213, v209, s49
    v_perm_b32 v202, v214, v210, s48
    v_perm_b32 v214, v214, v210, s49
    v_perm_b32 v203, v215, v211, s48
    v_perm_b32 v215, v215, v211, s49
    v_perm_b32 v208, v220, v216, s48
    v_perm_b32 v220, v220, v216, s49
    v_perm_b32 v209, v221, v217, s48
    v_perm_b32 v221, v221, v217, s49
    v_perm_b32 v210, v222, v218, s48
    v_perm_b32 v222, v222, v218, s49
    v_perm_b32 v211, v223, v219, s48
    v_perm_b32 v223, v223, v219, s49
    s_add_u32 s40, s40, 16384
    s_addc_u32 s41, s41, 0
    global_load_dword v240, v2, s[40:41] offset:0
    global_load_dword v248, v2, s[40:41] offset:64
    global_load_dword v244, v2, s[40:41] offset:512
    global_load_dword v252, v2, s[40:41] offset:576
    global_load_dword v241, v2, s[40:41] offset:1024
    global_load_dword v249, v2, s[40:41] offset:1088
    global_load_dword v245, v2, s[40:41] offset:1536
    global_load_dword v253, v2, s[40:41] offset:1600
    global_load_dword v242, v2, s[40:41] offset:2048
    global_load_dword v250, v2, s[40:41] offset:2112
    global_load_dword v246, v2, s[40:41] offset:2560
    global_load_dword v254, v2, s[40:41] offset:2624
    global_load_dword v243, v2, s[40:41] offset:3072
    global_load_dword v251, v2, s[40:41] offset:3136
    global_load_dword v247, v2, s[40:41] offset:3584
    global_load_dword v255, v2, s[40:41] offset:3648
    s_waitcnt vmcnt(16)
    v_perm_b32 v216, v228, v224, s48
    v_perm_b32 v228, v228, v224, s49
    v_perm_b32 v217, v229, v225, s48
    v_perm_b32 v229, v229, v225, s49
    v_perm_b32 v218, v230, v226, s48
    v_perm_b32 v230, v230, v226, s49
    v_perm_b32 v219, v231, v227, s48
    v_perm_b32 v231, v231, v227, s49
    v_perm_b32 v224, v236, v232, s48
    v_perm_b32 v236, v236, v232, s49
    v_perm_b32 v225, v237, v233, s48
    v_perm_b32 v237, v237, v233, s49
    v_perm_b32 v226, v238, v234, s48
    v_perm_b32 v238, v238, v234, s49
    v_perm_b32 v227, v239, v235, s48
    v_perm_b32 v239, v239, v235, s49
    s_waitcnt vmcnt(0)
    v_perm_b32 v232, v244, v240, s48
    v_perm_b32 v244, v244, v240, s49
    v_perm_b32 v233, v245, v241, s48
    v_perm_b32 v245, v245, v241, s49
    v_perm_b32 v234, v246, v242, s48
    v_perm_b32 v246, v246, v242, s49
    v_perm_b32 v235, v247, v243, s48
    v_perm_b32 v247, v247, v243, s49
    v_perm_b32 v240, v252, v248, s48
    v_perm_b32 v252, v252, v248, s49
    v_perm_b32 v241, v253, v249, s48
    v_perm_b32 v253, v253, v249, s49
    v_perm_b32 v242, v254, v250, s48
    v_perm_b32 v254, v254, v250, s49
    v_perm_b32 v243, v255, v251, s48
    v_perm_b32 v255, v255, v251, s49
    s_branch L_Awd
L_Ahelp:
    s_waitcnt vmcnt(0)
    s_mov_b64 exec, 1
    ds_add_u32 v1, v0 offset:43032
    s_mov_b64 exec, -1
    s_waitcnt lgkmcnt(0)
    s_endpgm
L_Awd:
    s_setprio 0
    s_mov_b64 exec, 1
L_sw_1:
    ds_read_b32 v12, v1 offset:43048
    s_waitcnt lgkmcnt(0)
    v_readfirstlane_b32 s52, v12
    s_cmp_ge_u32 s52, 4
    s_cbranch_scc1 L_sw_1_d
    s_sleep 1
    s_branch L_sw_1
L_sw_1_d:
    s_mov_b64 exec, -1
    s_lshl_b32 s52, s51, 15
    v_lshl_add_u32 v6, v1, 4, s52
    v_add_u32 v7, 0x4000, v6
    s_add_u32 s44, s28, 77824
    s_addc_u32 s45, s29, 0
    s_and_b32 s52, s2, 7
    s_lshl_b32 s52, s52, 10
    s_add_u32 s52, s52, 4096
    v_lshl_add_u32 v54, v1, 4, s52
    ds_read_b32 v55, v1 offset:43072
    s_mov_b32 s57, 0
    s_waitcnt lgkmcnt(0)
    v_readfirstlane_b32 s0, v55
L_mfp:
    global_load_dwordx4 v[20:23], v54, s[28:29] sc1
    s_waitcnt vmcnt(0)
    v_xor_b32 v20, s0, v20
    v_xor_b32 v21, s0, v21
    v_xor_b32 v22, s0, v22
    v_xor_b32 v23, s0, v23
    v_or3_b32 v20, v20, v21, v22
    v_or_b32 v20, v20, v23
    v_cmp_ne_u32 vcc, 0, v20
    s_cbranch_vccz L_mfok
    s_add_u32 s57, s57, 1
    s_cmp_gt_u32 s57, 0x40000
    s_cbranch_scc1 L_giveup
    s_sleep 4
    s_branch L_mfp
L_mfok:
    global_load_dwordx4 v[76:79], v6, s[36:37] offset:-4096 sc1
    global_load_dwordx4 v[80:83], v6, s[44:45] offset:-4096 sc1
    global_load_dwordx4 v[84:87], v7, s[36:37] offset:-4096 sc1
    global_load_dwordx4 v[88:91], v7, s[44:45] offset:-4096 sc1
    global_load_dwordx4 v[92:95], v6, s[36:37] offset:-3072 sc1
    global_load_dwordx4 v[96:99], v6, s[44:45] offset:-3072 sc1
    global_load_dwordx4 v[100:103], v7, s[36:37] offset:-3072 sc1
    global_load_dwordx4 v[104:107], v7, s[44:45] offset:-3072 sc1
    global_load_dwordx4 v[108:111], v6, s[36:37] offset:-2048 sc1
    global_load_dwordx4 v[112:115], v6, s[44:45] offset:-2048 sc1
    global_load_dwordx4 v[116:119], v7, s[36:37] offset:-2048 sc1
    global_load_dwordx4 v[120:123], v7, s[44:45] offset:-2048 sc1
    s_mov_b64 exec, 1
L_sw_2:
    ds_read_b32 v12, v1 offset:43036
    s_waitcnt lgkmcnt(0)
    v_readfirstlane_b32 s52, v12
    s_cmp_ge_u32 s52, 4
    s_cbranch_scc1 L_sw_2_d
    s_sleep 1
    s_branch L_sw_2
L_sw_2_d:
    s_mov_b64 exec, -1
    ds_read_b128 v[60:63], v8 offset:0
    ds_read_b128 v[64:67], v8 offset:8192
    ds_read_b128 v[68:71], v8 offset:16384
    ds_read_b128 v[72:75], v9 offset:0
    s_waitcnt vmcnt(8)
    s_waitcnt lgkmcnt(3)
    v_mfma_f32_16x16x32_bf16 v[12:15], v[76:79], v[60:63], 0
    v_mfma_f32_16x16x32_bf16 v[16:19], v[80:83], v[60:63], 0
    v_mfma_f32_16x16x32_bf16 v[20:23], v[84:87], v[60:63], 0
    v_mfma_f32_16x16x32_bf16 v[24:27], v[88:91], v[60:63], 0
    ds_read_b128 v[60:63], v9 offset:8192
    s_waitcnt lgkmcnt(3)
    v_mfma_f32_16x16x32_bf16 v[28:31], v[76:79], v[64:67], 0
    v_mfma_f32_16x16x32_bf16 v[32:35], v[80:83], v[64:67], 0
    v_mfma_f32_16x16x32_bf16 v[36:39], v[84:87], v[64:67], 0
    v_mfma_f32_16x16x32_bf16 v[40:43], v[88:91], v[64:67], 0
    ds_read_b128 v[64:67], v9 offset:16384
    s_waitcnt lgkmcnt(3)
    v_mfma_f32_16x16x32_bf16 v[44:47], v[76:79], v[68:71], 0
    s_setprio 3
    global_load_dwordx4 v[76:79], v6, s[36:37] offset:-1024 sc1
    v_mfma_f32_16x16x32_bf16 v[48:51], v[80:83], v[68:71], 0
    global_load_dwordx4 v[80:83], v6, s[44:45] offset:-1024 sc1
    v_mfma_f32_16x16x32_bf16 v[52:55], v[84:87], v[68:71], 0
    global_load_dwordx4 v[84:87], v7, s[36:37] offset:-1024 sc1
    v_mfma_f32_16x16x32_bf16 v[56:59], v[88:91], v[68:71], 0
    global_load_dwordx4 v[88:91], v7, s[44:45] offset:-1024 sc1
    s_setprio 0
    ds_read_b128 v[68:71], v10 offset:0
    s_add_u32 m0, s10, 12288
    v_xor_b32_dpp v2, v4, v3 row_newbcast:12 row_mask:0xf bank_mask:0xf
    buffer_load_dwordx4 v2, s[32:35], 0 offen sc1 lds
    s_add_u32 m0, s10, 13312
    v_xor_b32_dpp v2, v4, v3 row_newbcast:13 row_mask:0xf bank_mask:0xf
    buffer_load_dwordx4 v2, s[32:35], 0 offen sc1 lds
    s_add_u32 m0, s10, 14336
    v_xor_b32_dpp v2, v4, v3 row_newbcast:14 row_mask:0xf bank_mask:0xf
    buffer_load_dwordx4 v2, s[32:35], 0 offen sc1 lds
    s_waitcnt vmcnt(11)
    s_waitcnt lgkmcnt(3)
    v_mfma_f32_16x16x32_bf16 v[12:15], v[92:95], v[72:75], v[12:15]
    v_mfma_f32_16x16x32_bf16 v[16:19], v[96:99], v[72:75], v[16:19]
    v_mfma_f32_16x16x32_bf16 v[20:23], v[100:103], v[72:75], v[20:23]
    v_mfma_f32_16x16x32_bf16 v[24:27], v[104:107], v[72:75], v[24:27]
    ds_read_b128 v[72:75], v10 offset:8192
    s_waitcnt lgkmcnt(3)
    v_mfma_f32_16x16x32_bf16 v[28:31], v[92:95], v[60:63], v[28:31]
    v_mfma_f32_16x16x32_bf16 v[32:35], v[96:99], v[60:63], v[32:35]
    v_mfma_f32_16x16x32_bf16 v[36:39], v[100:103], v[60:63], v[36:39]
    v_mfma_f32_16x16x32_bf16 v[40:43], v[104:107], v[60:63], v[40:43]
    ds_read_b128 v[60:63], v10 offset:16384
    s_waitcnt lgkmcnt(3)
    v_mfma_f32_16x16x32_bf16 v[44:47], v[92:95], v[64:67], v[44:47]
    s_setprio 3
    global_load_dwordx4 v[92:95], v6, s[36:37] offset:0 sc1
    v_mfma_f32_16x16x32_bf16 v[48:51], v[96:99], v[64:67], v[48:51]
    global_load_dwordx4 v[96:99], v6, s[44:45] offset:0 sc1
    v_mfma_f32_16x16x32_bf16 v[52:55], v[100:103], v[64:67], v[52:55]
    global_load_dwordx4 v[100:103], v7, s[36:37] offset:0 sc1
    v_mfma_f32_16x16x32_bf16 v[56:59], v[104:107], v[64:67], v[56:59]
    global_load_dwordx4 v[104:107], v7, s[44:45] offset:0 sc1
    s_setprio 0
    ds_read_b128 v[64:67], v11 offset:0
    s_add_u32 m0, s10, 15360
    v_xor_b32_dpp v2, v4, v3 row_newbcast:15 row_mask:0xf bank_mask:0xf
    buffer_load_dwordx4 v2, s[32:35], 0 offen sc1 lds
    s_add_u32 m0, s10, 16384
    v_xor_b32_dpp v2, v5, v3 row_newbcast:0 row_mask:0xf bank_mask:0xf
    buffer_load_dwordx4 v2, s[32:35], 0 offen sc1 lds
    s_add_u32 m0, s10, 17408
    v_xor_b32_dpp v2, v5, v3 row_newbcast:1 row_mask:0xf bank_mask:0xf
    buffer_load_dwordx4 v2, s[32:35], 0 offen sc1 lds
    s_waitcnt vmcnt(14)
    s_waitcnt lgkmcnt(3)
    v_mfma_f32_16x16x32_bf16 v[12:15], v[108:111], v[68:71], v[12:15]
    v_mfma_f32_16x16x32_bf16 v[16:19], v[112:115], v[68:71], v[16:19]
    v_mfma_f32_16x16x32_bf16 v[20:23], v[116:119], v[68:71], v[20:23]
    v_mfma_f32_16x16x32_bf16 v[24:27], v[120:123], v[68:71], v[24:27]
    ds_read_b128 v[68:71], v11 offset:8192
    s_waitcnt lgkmcnt(3)
    v_mfma_f32_16x16x32_bf16 v[28:31], v[108:111], v[72:75], v[28:31]
    v_mfma_f32_16x16x32_bf16 v[32:35], v[112:115], v[72:75], v[32:35]
    v_mfma_f32_16x16x32_bf16 v[36:39], v[116:119], v[72:75], v[36:39]
    v_mfma_f32_16x16x32_bf16 v[40:43], v[120:123], v[72:75], v[40:43]
    ds_read_b128 v[72:75], v11 offset:16384
    s_waitcnt lgkmcnt(3)
    v_mfma_f32_16x16x32_bf16 v[44:47], v[108:111], v[60:63], v[44:47]
    s_setprio 3
    global_load_dwordx4 v[108:111], v6, s[36:37] offset:1024 sc1
    v_mfma_f32_16x16x32_bf16 v[48:51], v[112:115], v[60:63], v[48:51]
    global_load_dwordx4 v[112:115], v6, s[44:45] offset:1024 sc1
    v_mfma_f32_16x16x32_bf16 v[52:55], v[116:119], v[60:63], v[52:55]
    global_load_dwordx4 v[116:119], v7, s[36:37] offset:1024 sc1
    v_mfma_f32_16x16x32_bf16 v[56:59], v[120:123], v[60:63], v[56:59]
    global_load_dwordx4 v[120:123], v7, s[44:45] offset:1024 sc1
    s_setprio 0
    ds_read_b128 v[60:63], v8 offset:256
    s_add_u32 m0, s10, 18432
    v_xor_b32_dpp v2, v5, v3 row_newbcast:2 row_mask:0xf bank_mask:0xf
    buffer_load_dwordx4 v2, s[32:35], 0 offen sc1 lds
    s_add_u32 m0, s10, 19456
    v_xor_b32_dpp v2, v5, v3 row_newbcast:3 row_mask:0xf bank_mask:0xf
    buffer_load_dwordx4 v2, s[32:35], 0 offen sc1 lds
    s_waitcnt vmcnt(16)
    s_waitcnt lgkmcnt(3)
    v_mfma_f32_16x16x32_bf16 v[12:15], v[76:79], v[64:67], v[12:15]
    v_mfma_f32_16x16x32_bf16 v[16:19], v[80:83], v[64:67], v[16:19]
    v_mfma_f32_16x16x32_bf16 v[20:23], v[84:87], v[64:67], v[20:23]
    v_mfma_f32_16x16x32_bf16 v[24:27], v[88:91], v[64:67], v[24:27]
    ds_read_b128 v[64:67], v8 offset:8448
    s_waitcnt lgkmcnt(3)
    v_mfma_f32_16x16x32_bf16 v[28:31], v[76:79], v[68:71], v[28:31]
    v_mfma_f32_16x16x32_bf16 v[32:35], v[80:83], v[68:71], v[32:35]
    v_mfma_f32_16x16x32_bf16 v[36:39], v[84:87], v[68:71], v[36:39]
    v_mfma_f32_16x16x32_bf16 v[40:43], v[88:91], v[68:71], v[40:43]
    ds_read_b128 v[68:71], v8 offset:16640
    s_waitcnt lgkmcnt(3)
    v_mfma_f32_16x16x32_bf16 v[44:47], v[76:79], v[72:75], v[44:47]
    s_setprio 3
    global_load_dwordx4 v[76:79], v6, s[36:37] offset:2048 sc1
    v_mfma_f32_16x16x32_bf16 v[48:51], v[80:83], v[72:75], v[48:51]
    global_load_dwordx4 v[80:83], v6, s[44:45] offset:2048 sc1
    v_mfma_f32_16x16x32_bf16 v[52:55], v[84:87], v[72:75], v[52:55]
    global_load_dwordx4 v[84:87], v7, s[36:37] offset:2048 sc1
    v_mfma_f32_16x16x32_bf16 v[56:59], v[88:91], v[72:75], v[56:59]
    global_load_dwordx4 v[88:91], v7, s[44:45] offset:2048 sc1
    s_setprio 0
    ds_read_b128 v[72:75], v9 offset:256
    s_waitcnt vmcnt(13)
    s_waitcnt lgkmcnt(3)
    v_mfma_f32_16x16x32_bf16 v[12:15], v[92:95], v[60:63], v[12:15]
    v_mfma_f32_16x16x32_bf16 v[16:19], v[96:99], v[60:63], v[16:19]
    v_mfma_f32_16x16x32_bf16 v[20:23], v[100:103], v[60:63], v[20:23]
    v_mfma_f32_16x16x32_bf16 v[24:27], v[104:107], v[60:63], v[24:27]
    ds_read_b128 v[60:63], v9 offset:8448
    s_waitcnt lgkmcnt(3)
    v_mfma_f32_16x16x32_bf16 v[28:31], v[92:95], v[64:67], v[28:31]
    v_mfma_f32_16x16x32_bf16 v[32:35], v[96:99], v[64:67], v[32:35]
    v_mfma_f32_16x16x32_bf16 v[36:39], v[100:103], v[64:67], v[36:39]
    v_mfma_f32_16x16x32_bf16 v[40:43], v[104:107], v[64:67], v[40:43]
    ds_read_b128 v[64:67], v9 offset:16640
    s_waitcnt lgkmcnt(3)
    v_mfma_f32_16x16x32_bf16 v[44:47], v[92:95], v[68:71], v[44:47]
    s_setprio 3
    global_load_dwordx4 v[92:95], v6, s[36:37] offset:3072 sc1
    v_mfma_f32_16x16x32_bf16 v[48:51], v[96:99], v[68:71], v[48:51]
    global_load_dwordx4 v[96:99], v6, s[44:45] offset:3072 sc1
    v_mfma_f32_16x16x32_bf16 v[52:55], v[100:103], v[68:71], v[52:55]
    global_load_dwordx4 v[100:103], v7, s[36:37] offset:3072 sc1
    v_mfma_f32_16x16x32_bf16 v[56:59], v[104:107], v[68:71], v[56:59]
    global_load_dwordx4 v[104:107], v7, s[44:45] offset:3072 sc1
    s_setprio 0
    ds_read_b128 v[68:71], v10 offset:256
    s_waitcnt vmcnt(10)
    s_waitcnt lgkmcnt(3)
    v_mfma_f32_16x16x32_bf16 v[12:15], v[108:111], v[72:75], v[12:15]
    v_mfma_f32_16x16x32_bf16 v[16:19], v[112:115], v[72:75], v[16:19]
    v_mfma_f32_16x16x32_bf16 v[20:23], v[116:119], v[72:75], v[20:23]
    v_mfma_f32_16x16x32_bf16 v[24:27], v[120:123], v[72:75], v[24:27]
    ds_read_b128 v[72:75], v10 offset:8448
    s_waitcnt lgkmcnt(3)
    v_mfma_f32_16x16x32_bf16 v[28:31], v[108:111], v[60:63], v[28:31]
    v_mfma_f32_16x16x32_bf16 v[32:35], v[112:115], v[60:63], v[32:35]
    v_mfma_f32_16x16x32_bf16 v[36:39], v[116:119], v[60:63], v[36:39]
    v_mfma_f32_16x16x32_bf16 v[40:43], v[120:123], v[60:63], v[40:43]
    ds_read_b128 v[60:63], v10 offset:16640
    s_waitcnt lgkmcnt(3)
    v_mfma_f32_16x16x32_bf16 v[44:47], v[108:111], v[64:67], v[44:47]
    v_mfma_f32_16x16x32_bf16 v[48:51], v[112:115], v[64:67], v[48:51]
    v_mfma_f32_16x16x32_bf16 v[52:55], v[116:119], v[64:67], v[52:55]
    v_mfma_f32_16x16x32_bf16 v[56:59], v[120:123], v[64:67], v[56:59]
    ds_read_b128 v[64:67], v11 offset:256
    s_waitcnt vmcnt(4)
    s_waitcnt lgkmcnt(3)
    v_mfma_f32_16x16x32_bf16 v[12:15], v[76:79], v[68:71], v[12:15]
    v_mfma_f32_16x16x32_bf16 v[16:19], v[80:83], v[68:71], v[16:19]
    v_mfma_f32_16x16x32_bf16 v[20:23], v[84:87], v[68:71], v[20:23]
    v_mfma_f32_16x16x32_bf16 v[24:27], v[88:91], v[68:71], v[24:27]
    ds_read_b128 v[68:71], v11 offset:8448
    s_waitcnt lgkmcnt(3)
    v_mfma_f32_16x16x32_bf16 v[28:31], v[76:79], v[72:75], v[28:31]
    v_mfma_f32_16x16x32_bf16 v[32:35], v[80:83], v[72:75], v[32:35]
    v_mfma_f32_16x16x32_bf16 v[36:39], v[84:87], v[72:75], v[36:39]
    v_mfma_f32_16x16x32_bf16 v[40:43], v[88:91], v[72:75], v[40:43]
    ds_read_b128 v[72:75], v11 offset:16640
    s_waitcnt lgkmcnt(3)
    v_mfma_f32_16x16x32_bf16 v[44:47], v[76:79], v[60:63], v[44:47]
    v_mfma_f32_16x16x32_bf16 v[48:51], v[80:83], v[60:63], v[48:51]
    v_mfma_f32_16x16x32_bf16 v[52:55], v[84:87], v[60:63], v[52:55]
    v_mfma_f32_16x16x32_bf16 v[56:59], v[88:91], v[60:63], v[56:59]
    s_waitcnt vmcnt(0)
    s_waitcnt lgkmcnt(2)
    v_mfma_f32_16x16x32_bf16 v[12:15], v[92:95], v[64:67], v[12:15]
    v_mfma_f32_16x16x32_bf16 v[16:19], v[96:99], v[64:67], v[16:19]
    v_mfma_f32_16x16x32_bf16 v[20:23], v[100:103], v[64:67], v[20:23]
    v_mfma_f32_16x16x32_bf16 v[24:27], v[104:107], v[64:67], v[24:27]
    s_waitcnt lgkmcnt(1)
    v_mfma_f32_16x16x32_bf16 v[28:31], v[92:95], v[68:71], v[28:31]
    v_mfma_f32_16x16x32_bf16 v[32:35], v[96:99], v[68:71], v[32:35]
    v_mfma_f32_16x16x32_bf16 v[36:39], v[100:103], v[68:71], v[36:39]
    v_mfma_f32_16x16x32_bf16 v[40:43], v[104:107], v[68:71], v[40:43]
    s_waitcnt lgkmcnt(0)
    v_mfma_f32_16x16x32_bf16 v[44:47], v[92:95], v[72:75], v[44:47]
    v_mfma_f32_16x16x32_bf16 v[48:51], v[96:99], v[72:75], v[48:51]
    v_mfma_f32_16x16x32_bf16 v[52:55], v[100:103], v[72:75], v[52:55]
    v_mfma_f32_16x16x32_bf16 v[56:59], v[104:107], v[72:75], v[56:59]
    v_and_b32 v120, 15, v1
    v_lshrrev_b32 v121, 4, v1
    v_lshlrev_b32 v121, 1, v121
    s_lshl_b32 s52, s3, 3
    v_add_u32 v121, s52, v121
    v_xor_b32 v121, v121, v120
    v_lshlrev_b32 v121, 4, v121
    v_lshl_or_b32 v121, v120, 9, v121
    v_add_u32 v116, 81920, v121
    v_xor_b32 v117, 16, v116
    v_add_u32 v118, 0x10000, v116
    v_add_u32 v119, 0x10000, v117
    s_mul_i32 s52, s3, 768
    s_add_u32 s52, s52, 55296
    v_lshl_add_u32 v120, v120, 4, s52
    v_cvt_pk_bf16_f32 v60, v12, v16
    v_cvt_pk_bf16_f32 v61, v20, v24
    v_cvt_pk_bf16_f32 v62, v13, v17
    v_cvt_pk_bf16_f32 v63, v21, v25
    v_cvt_pk_bf16_f32 v64, v14, v18
    v_cvt_pk_bf16_f32 v65, v22, v26
    v_cvt_pk_bf16_f32 v66, v15, v19
    v_cvt_pk_bf16_f32 v67, v23, v27
    v_cvt_pk_bf16_f32 v68, v28, v32
    v_cvt_pk_bf16_f32 v69, v36, v40
    v_cvt_pk_bf16_f32 v70, v29, v33
    v_cvt_pk_bf16_f32 v71, v37, v41
    v_cvt_pk_bf16_f32 v72, v30, v34
    v_cvt_pk_bf16_f32 v73, v38, v42
    v_cvt_pk_bf16_f32 v74, v31, v35
    v_cvt_pk_bf16_f32 v75, v39, v43
    v_cvt_pk_bf16_f32 v76, v44, v48
    v_cvt_pk_bf16_f32 v77, v52, v56
    v_cvt_pk_bf16_f32 v78, v45, v49
    v_cvt_pk_bf16_f32 v79, v53, v57
    v_cvt_pk_bf16_f32 v80, v46, v50
    v_cvt_pk_bf16_f32 v81, v54, v58
    v_cvt_pk_bf16_f32 v82, v47, v51
    v_cvt_pk_bf16_f32 v83, v55, v59
    s_mov_b64 exec, 1
    ds_add_u32 v1, v0 offset:43008
    s_mov_b64 exec, -1
    s_mov_b64 exec, 1
L_sw_3:
    ds_read_b32 v121, v1 offset:43008
    s_waitcnt lgkmcnt(0)
    v_readfirstlane_b32 s52, v121
    s_cmp_ge_u32 s52, 8
    s_cbranch_scc1 L_sw_3_d
    s_sleep 1
    s_branch L_sw_3
L_sw_3_d:
    s_mov_b64 exec, -1
    ds_read_b128 v[12:15], v116 offset:0
    ds_read_b128 v[16:19], v117 offset:0
    ds_read_b128 v[20:23], v116 offset:8192
    ds_read_b128 v[24:27], v117 offset:8192
    ds_read_b128 v[28:31], v116 offset:16384
    ds_read_b128 v[32:35], v117 offset:16384
    ds_read_b128 v[36:39], v116 offset:24576
    ds_read_b128 v[40:43], v117 offset:24576
    ds_read_b128 v[44:47], v116 offset:32768
    ds_read_b128 v[48:51], v117 offset:32768
    ds_read_b128 v[52:55], v116 offset:40960
    ds_read_b128 v[56:59], v117 offset:40960
    s_waitcnt lgkmcnt(11)
    v_mfma_f32_16x16x32_bf16 v[84:87], v[12:15], v[60:63], 0
    ds_read_b128 v[12:15], v116 offset:49152
    s_waitcnt lgkmcnt(11)
    v_mfma_f32_16x16x32_bf16 v[84:87], v[16:19], v[64:67], v[84:87]
    ds_read_b128 v[16:19], v117 offset:49152
    s_waitcnt lgkmcnt(11)
    v_mfma_f32_16x16x32_bf16 v[88:91], v[20:23], v[60:63], 0
    ds_read_b128 v[20:23], v116 offset:57344
    s_waitcnt lgkmcnt(11)
    v_mfma_f32_16x16x32_bf16 v[88:91], v[24:27], v[64:67], v[88:91]
    ds_read_b128 v[24:27], v117 offset:57344
    s_waitcnt lgkmcnt(11)
    v_mfma_f32_16x16x32_bf16 v[92:95], v[28:31], v[60:63], 0
    ds_read_b128 v[28:31], v118 offset:0
    s_waitcnt lgkmcnt(11)
    v_mfma_f32_16x16x32_bf16 v[92:95], v[32:35], v[64:67], v[92:95]
    ds_read_b128 v[32:35], v119 offset:0
    s_waitcnt lgkmcnt(11)
    v_mfma_f32_16x16x32_bf16 v[96:99], v[36:39], v[60:63], 0
    ds_read_b128 v[36:39], v118 offset:8192
    s_waitcnt lgkmcnt(11)
    v_mfma_f32_16x16x32_bf16 v[96:99], v[40:43], v[64:67], v[96:99]
    ds_read_b128 v[40:43], v119 offset:8192
    s_waitcnt lgkmcnt(11)
    v_mfma_f32_16x16x32_bf16 v[100:103], v[44:47], v[68:71], 0
    s_waitcnt lgkmcnt(10)
    v_mfma_f32_16x16x32_bf16 v[100:103], v[48:51], v[72:75], v[100:103]
    s_waitcnt lgkmcnt(9)
    v_mfma_f32_16x16x32_bf16 v[104:107], v[52:55], v[68:71], 0
    s_waitcnt lgkmcnt(8)
    v_mfma_f32_16x16x32_bf16 v[104:107], v[56:59], v[72:75], v[104:107]
    s_waitcnt lgkmcnt(7)
    v_mfma_f32_16x16x32_bf16 v[108:111], v[12:15], v[68:71], 0
    s_waitcnt lgkmcnt(6)
    v_mfma_f32_16x16x32_bf16 v[108:111], v[16:19], v[72:75], v[108:111]
    s_waitcnt lgkmcnt(5)
    v_mfma_f32_16x16x32_bf16 v[112:115], v[20:23], v[68:71], 0
    s_waitcnt lgkmcnt(4)
    v_mfma_f32_16x16x32_bf16 v[112:115], v[24:27], v[72:75], v[112:115]
    s_mov_b32 exec_lo, 0xf000f0
    s_mov_b32 exec_hi, 0xf000f0
    v_mov_b64 v[84:85], v[88:89]
    v_mov_b64 v[86:87], v[90:91]
    s_mov_b32 exec_lo, 0xf000f00
    s_mov_b32 exec_hi, 0xf000f00
    v_mov_b64 v[84:85], v[92:93]
    v_mov_b64 v[86:87], v[94:95]
    s_mov_b32 exec_lo, 0xf000f000
    s_mov_b32 exec_hi, 0xf000f000
    v_mov_b64 v[84:85], v[96:97]
    v_mov_b64 v[86:87], v[98:99]
    s_mov_b32 exec_lo, 0x22221111
    s_mov_b32 exec_hi, 0x88884444
    ds_write_b128 v120, v[84:87] offset:0
    s_mov_b64 exec, -1
    s_waitcnt lgkmcnt(4)
    v_mfma_f32_16x16x32_bf16 v[84:87], v[28:31], v[76:79], 0
    s_waitcnt lgkmcnt(3)
    v_mfma_f32_16x16x32_bf16 v[84:87], v[32:35], v[80:83], v[84:87]
    s_waitcnt lgkmcnt(2)
    v_mfma_f32_16x16x32_bf16 v[88:91], v[36:39], v[76:79], 0
    s_waitcnt lgkmcnt(1)
    v_mfma_f32_16x16x32_bf16 v[88:91], v[40:43], v[80:83], v[88:91]
    s_nop 0
    s_mov_b32 exec_lo, 0xf000f0
    s_mov_b32 exec_hi, 0xf000f0
    v_mov_b64 v[100:101], v[104:105]
    v_mov_b64 v[102:103], v[106:107]
    s_mov_b32 exec_lo, 0xf000f00
    s_mov_b32 exec_hi, 0xf000f00
    v_mov_b64 v[100:101], v[108:109]
    v_mov_b64 v[102:103], v[110:111]
    s_mov_b32 exec_lo, 0xf000f000
    s_mov_b32 exec_hi, 0xf000f000
    v_mov_b64 v[100:101], v[112:113]
    v_mov_b64 v[102:103], v[114:115]
    s_mov_b32 exec_lo, 0x22221111
    s_mov_b32 exec_hi, 0x88884444
    ds_write_b128 v120, v[100:103] offset:256
    s_mov_b64 exec, -1
    s_nop 1
    s_mov_b32 exec_lo, 0xf000f0
    s_mov_b32 exec_hi, 0xf000f0
    v_mov_b64 v[84:85], v[88:89]
    v_mov_b64 v[86:87], v[90:91]
    s_mov_b32 exec_lo, 0x22221111
    s_mov_b32 exec_hi, 0x88884444
    ds_write_b128 v120, v[84:87] offset:512
    s_mov_b64 exec, -1
    s_waitcnt lgkmcnt(0)
    s_mov_b64 exec, 1
    ds_add_u32 v1, v0 offset:43012
    s_mov_b64 exec, -1
    v_lshrrev_b32 v44, 4, v1
    v_and_b32 v45, 1, v44
    v_bfe_u32 v46, v1, 2, 2
    v_lshl_add_u32 v46, v45, 2, v46
    v_lshlrev_b32 v46, 1, v46
    v_lshrrev_b32 v47, 1, v44
    v_lshl_add_u32 v48, v47, 4, v46
    v_lshlrev_b32 v48, 9, v48
    v_bfe_u32 v49, v1, 1, 1
    s_lshl_b32 s53, s3, 3
    v_add_u32 v49, s53, v49
    v_xor_b32 v49, v49, v46
    v_lshl_add_u32 v48, v49, 4, v48
    v_and_b32 v49, 1, v1
    v_lshl_add_u32 v48, v49, 3, v48
    v_add_u32 v108, 81920, v48
    v_xor_b32 v109, 16, v108
    v_xor_b32 v110, 32, v108
    v_xor_b32 v111, 48, v108
    v_xor_b32 v112, 64, v108
    v_xor_b32 v113, 80, v108
    v_xor_b32 v114, 96, v108
    v_xor_b32 v115, 112, v108
    v_and_b32 v46, 15, v1
    v_add_u32 v47, s53, v47
    v_xor_b32 v47, v47, v46
    v_lshlrev_b32 v47, 4, v47
    v_lshl_or_b32 v47, v46, 9, v47
    v_lshl_or_b32 v2, v45, 3, v47
    v_xor_b32 v3, 32, v2
    v_xor_b32 v4, 64, v2
    v_xor_b32 v5, 0x60, v2
    s_lshl_b32 s53, s3, 9
    s_add_u32 s53, s53, 58368
    v_lshl_add_u32 v116, v1, 3, s53
    v_lshl_add_u32 v117, v46, 3, s53
    v_lshlrev_b32 v118, 4, v1
    ds_read_b64_tr_b16 v[12:13], v108 offset:0
    ds_read_b64_tr_b16 v[14:15], v109 offset:512
    ds_read_b64_tr_b16 v[16:17], v110 offset:0
    ds_read_b64_tr_b16 v[18:19], v111 offset:512
    ds_read_b64_tr_b16 v[20:21], v112 offset:0
    ds_read_b64_tr_b16 v[22:23], v113 offset:512
    ds_read_b64_tr_b16 v[24:25], v114 offset:0
    ds_read_b64_tr_b16 v[26:27], v115 offset:512
    s_mov_b32 s60, 0x40001
    s_mov_b32 s61, 0x400010
    s_mov_b32 s62, 0x80002
    s_mov_b32 s63, 0x800020
    s_mov_b32 s64, 0x4000100
    s_mov_b32 s65, 0x40001000
    s_mov_b32 s66, 0x8000200
    s_mov_b32 s67, 0x80002000
    s_mov_b64 exec, 1
L_sw_4:
    ds_read_b32 v121, v1 offset:43012
    s_waitcnt lgkmcnt(0)
    v_readfirstlane_b32 s52, v121
    s_cmp_ge_u32 s52, 4
    s_cbranch_scc1 L_sw_4_d
    s_sleep 1
    s_branch L_sw_4
L_sw_4_d:
    s_mov_b64 exec, -1
    ds_read_b128 v[60:63], v118 offset:55296
    ds_read_b128 v[64:67], v118 offset:56064
    ds_read_b128 v[68:71], v118 offset:56832
    ds_read_b128 v[72:75], v118 offset:57600
    ds_read_b64_tr_b16 v[28:29], v108 offset:16384
    ds_read_b64_tr_b16 v[30:31], v109 offset:16896
    ds_read_b64_tr_b16 v[32:33], v110 offset:16384
    ds_read_b64_tr_b16 v[34:35], v111 offset:16896
    ds_read_b64_tr_b16 v[36:37], v112 offset:16384
    ds_read_b64_tr_b16 v[38:39], v113 offset:16896
    ds_read_b64_tr_b16 v[40:41], v114 offset:16384
    ds_read_b64_tr_b16 v[42:43], v115 offset:16896
    s_waitcnt lgkmcnt(10)
    v_pk_add_f32 v[60:61], v[60:61], v[64:65]
    v_pk_add_f32 v[62:63], v[62:63], v[66:67]
    s_waitcnt lgkmcnt(8)
    v_pk_add_f32 v[68:69], v[68:69], v[72:73]
    v_pk_add_f32 v[70:71], v[70:71], v[74:75]
    v_pk_add_f32 v[60:61], v[60:61], v[68:69]
    v_pk_add_f32 v[62:63], v[62:63], v[70:71]
    s_mov_b32 s52, 0x3db8aa3b
    v_mul_f32 v60, s52, v60
    v_mul_f32 v61, s52, v61
    v_mul_f32 v62, s52, v62
    v_mul_f32 v63, s52, v63
    v_exp_f32 v60, v60
    v_exp_f32 v61, v61
    v_exp_f32 v62, v62
    v_exp_f32 v63, v63
    s_nop 0
    v_add_f32 v64, v60, v61
    v_add_f32 v65, v62, v63
    v_add_f32 v64, v64, v65
    v_add_f32 v64, 0x3089705f, v64
    v_rcp_f32 v64, v64
    s_nop 0
    v_mul_f32 v60, v60, v64
    v_mul_f32 v61, v61, v64
    v_mul_f32 v62, v62, v64
    v_mul_f32 v63, v63, v64
    v_cvt_pk_bf16_f32 v66, v60, v62
    v_cvt_pk_bf16_f32 v67, v61, v63
    ds_write_b64 v116, v[66:67]
    ds_read_b64 v[68:69], v117
    ds_read_b64 v[70:71], v117 offset:128
    ds_read_b64 v[72:73], v117 offset:256
    s_waitcnt lgkmcnt(2)
    v_cndmask_b32 v60, 0, v68, s[60:61]
    v_cndmask_b32 v61, 0, v68, s[62:63]
    v_cndmask_b32 v62, 0, v69, s[60:61]
    v_cndmask_b32 v63, 0, v69, s[62:63]
    ds_read_b64_tr_b16 v[44:45], v108 offset:32768
    ds_read_b64_tr_b16 v[46:47], v109 offset:33280
    ds_read_b64_tr_b16 v[48:49], v110 offset:32768
    ds_read_b64_tr_b16 v[50:51], v111 offset:33280
    ds_read_b64_tr_b16 v[52:53], v112 offset:32768
    ds_read_b64_tr_b16 v[54:55], v113 offset:33280
    ds_read_b64_tr_b16 v[56:57], v114 offset:32768
    ds_read_b64_tr_b16 v[58:59], v115 offset:33280
    v_mfma_f32_16x16x32_bf16 v[76:79], v[12:15], v[60:63], 0
    v_mfma_f32_16x16x32_bf16 v[80:83], v[16:19], v[60:63], 0
    v_mfma_f32_16x16x32_bf16 v[84:87], v[20:23], v[60:63], 0
    v_mfma_f32_16x16x32_bf16 v[88:91], v[24:27], v[60:63], 0
    v_cndmask_b32 v64, 0, v68, s[64:65]
    v_cndmask_b32 v65, 0, v68, s[66:67]
    v_cndmask_b32 v66, 0, v69, s[64:65]
    v_cndmask_b32 v67, 0, v69, s[66:67]
    s_nop 1
    v_mfma_f32_16x16x32_bf16 v[76:79], v[28:31], v[64:67], v[76:79]
    v_mfma_f32_16x16x32_bf16 v[80:83], v[32:35], v[64:67], v[80:83]
    v_mfma_f32_16x16x32_bf16 v[84:87], v[36:39], v[64:67], v[84:87]
    v_mfma_f32_16x16x32_bf16 v[88:91], v[40:43], v[64:67], v[88:91]
    ds_read_b64_tr_b16 v[12:13], v108 offset:49152
    ds_read_b64_tr_b16 v[14:15], v109 offset:49664
    ds_read_b64_tr_b16 v[16:17], v110 offset:49152
    ds_read_b64_tr_b16 v[18:19], v111 offset:49664
    ds_read_b64_tr_b16 v[20:21], v112 offset:49152
    s_waitcnt lgkmcnt(14)
    ds_read_b64_tr_b16 v[22:23], v113 offset:49664
    s_waitcnt lgkmcnt(14)
    ds_read_b64_tr_b16 v[24:25], v114 offset:49152
    s_waitcnt lgkmcnt(14)
    ds_read_b64_tr_b16 v[26:27], v115 offset:49664
    v_cndmask_b32 v60, 0, v70, s[60:61]
    v_cndmask_b32 v61, 0, v70, s[62:63]
    v_cndmask_b32 v62, 0, v71, s[60:61]
    v_cndmask_b32 v63, 0, v71, s[62:63]
    s_waitcnt lgkmcnt(8)
    s_nop 1
    v_mfma_f32_16x16x32_bf16 v[92:95], v[44:47], v[60:63], 0
    v_mfma_f32_16x16x32_bf16 v[96:99], v[48:51], v[60:63], 0
    v_mfma_f32_16x16x32_bf16 v[100:103], v[52:55], v[60:63], 0
    v_mfma_f32_16x16x32_bf16 v[104:107], v[56:59], v[60:63], 0
    v_add_u32 v108, 0x10000, v108
    v_add_u32 v109, 0x10000, v109
    v_add_u32 v110, 0x10000, v110
    v_add_u32 v111, 0x10000, v111
    v_add_u32 v112, 0x10000, v112
    v_add_u32 v113, 0x10000, v113
    v_add_u32 v114, 0x10000, v114
    v_add_u32 v115, 0x10000, v115
    ds_read_b64_tr_b16 v[28:29], v108 offset:0
    ds_read_b64_tr_b16 v[30:31], v109 offset:512
    ds_read_b64_tr_b16 v[32:33], v110 offset:0
    ds_read_b64_tr_b16 v[34:35], v111 offset:512
    ds_read_b64_tr_b16 v[36:37], v112 offset:0
    ds_read_b64_tr_b16 v[38:39], v113 offset:512
    ds_read_b64_tr_b16 v[40:41], v114 offset:0
    s_waitcnt lgkmcnt(14)
    ds_read_b64_tr_b16 v[42:43], v115 offset:512
    v_cvt_pk_bf16_f32 v120, v76, v77
    v_cvt_pk_bf16_f32 v121, v78, v79
    s_waitcnt lgkmcnt(14)
    ds_write_b64 v2, v[120:121] offset:0
    v_cvt_pk_bf16_f32 v122, v80, v81
    v_cvt_pk_bf16_f32 v123, v82, v83
    s_waitcnt lgkmcnt(14)
    ds_write_b64 v3, v[122:123] offset:0
    v_cvt_pk_bf16_f32 v120, v84, v85
    v_cvt_pk_bf16_f32 v121, v86, v87
    s_waitcnt lgkmcnt(14)
    ds_write_b64 v4, v[120:121] offset:0
    v_cvt_pk_bf16_f32 v122, v88, v89
    v_cvt_pk_bf16_f32 v123, v90, v91
    s_waitcnt lgkmcnt(14)
    ds_write_b64 v5, v[122:123] offset:0
    v_cndmask_b32 v64, 0, v70, s[64:65]
    v_cndmask_b32 v65, 0, v70, s[66:67]
    v_cndmask_b32 v66, 0, v71, s[64:65]
    v_cndmask_b32 v67, 0, v71, s[66:67]
    s_waitcnt lgkmcnt(12)
    s_nop 1
    v_mfma_f32_16x16x32_bf16 v[92:95], v[12:15], v[64:67], v[92:95]
    v_mfma_f32_16x16x32_bf16 v[96:99], v[16:19], v[64:67], v[96:99]
    v_mfma_f32_16x16x32_bf16 v[100:103], v[20:23], v[64:67], v[100:103]
    v_mfma_f32_16x16x32_bf16 v[104:107], v[24:27], v[64:67], v[104:107]
    v_cndmask_b32 v60, 0, v72, s[60:61]
    v_cndmask_b32 v61, 0, v72, s[62:63]
    v_cndmask_b32 v62, 0, v73, s[60:61]
    v_cndmask_b32 v63, 0, v73, s[62:63]
    s_waitcnt lgkmcnt(4)
    s_nop 1
    v_mfma_f32_16x16x32_bf16 v[76:79], v[28:31], v[60:63], 0
    v_mfma_f32_16x16x32_bf16 v[80:83], v[32:35], v[60:63], 0
    v_mfma_f32_16x16x32_bf16 v[84:87], v[36:39], v[60:63], 0
    v_mfma_f32_16x16x32_bf16 v[88:91], v[40:43], v[60:63], 0
    v_cvt_pk_bf16_f32 v120, v92, v93
    v_cvt_pk_bf16_f32 v121, v94, v95
    ds_write_b64 v2, v[120:121] offset:8192
    v_cvt_pk_bf16_f32 v122, v96, v97
    v_cvt_pk_bf16_f32 v123, v98, v99
    ds_write_b64 v3, v[122:123] offset:8192
    v_cvt_pk_bf16_f32 v120, v100, v101
    v_cvt_pk_bf16_f32 v121, v102, v103
    ds_write_b64 v4, v[120:121] offset:8192
    v_cvt_pk_bf16_f32 v122, v104, v105
    v_cvt_pk_bf16_f32 v123, v106, v107
    ds_write_b64 v5, v[122:123] offset:8192
    s_nop 3
    v_cvt_pk_bf16_f32 v120, v76, v77
    v_cvt_pk_bf16_f32 v121, v78, v79
    s_mov_b32 exec_lo, 0x00ff00ff
    s_mov_b32 exec_hi, 0x00ff00ff
    ds_write_b64 v2, v[120:121] offset:16384
    s_mov_b64 exec, -1
    v_cvt_pk_bf16_f32 v122, v80, v81
    v_cvt_pk_bf16_f32 v123, v82, v83
    s_mov_b32 exec_lo, 0x00ff00ff
    s_mov_b32 exec_hi, 0x00ff00ff
    ds_write_b64 v3, v[122:123] offset:16384
    s_mov_b64 exec, -1
    v_cvt_pk_bf16_f32 v120, v84, v85
    v_cvt_pk_bf16_f32 v121, v86, v87
    s_mov_b32 exec_lo, 0x00ff00ff
    s_mov_b32 exec_hi, 0x00ff00ff
    ds_write_b64 v4, v[120:121] offset:16384
    s_mov_b64 exec, -1
    v_cvt_pk_bf16_f32 v122, v88, v89
    v_cvt_pk_bf16_f32 v123, v90, v91
    s_mov_b32 exec_lo, 0x00ff00ff
    s_mov_b32 exec_hi, 0x00ff00ff
    ds_write_b64 v5, v[122:123] offset:16384
    s_mov_b64 exec, -1
    s_waitcnt lgkmcnt(0)
    s_mov_b64 exec, 1
    ds_add_u32 v1, v0 offset:43016
    s_mov_b64 exec, -1
    s_mov_b64 exec, 1
L_sw_5:
    ds_read_b32 v121, v1 offset:43016
    s_waitcnt lgkmcnt(0)
    v_readfirstlane_b32 s52, v121
    s_cmp_ge_u32 s52, 4
    s_cbranch_scc1 L_sw_5_d
    s_sleep 1
    s_branch L_sw_5
L_sw_5_d:
    s_mov_b64 exec, -1
L_noatt:
    ds_read_b128 v[12:15], v8 offset:0
    ds_read_b128 v[16:19], v8 offset:8192
    ds_read_b128 v[20:23], v8 offset:16384
    ds_read_b128 v[24:27], v9 offset:0
    ds_read_b128 v[28:31], v9 offset:8192
    ds_read_b128 v[32:35], v9 offset:16384
    v_and_b32 v56, 15, v1
    v_lshrrev_b32 v57, 4, v1
    s_lshl_b32 s52, s3, 7
    s_mul_i32 s55, s2, 20480
    s_add_u32 s44, s24, s55
    s_addc_u32 s45, s25, 0
    v_lshlrev_b32 v59, 11, v57
    v_lshl_add_u32 v59, v56, 2, v59
    v_add_u32 v59, s52, v59
    s_lshl_b32 s52, s3, 15
    s_add_u32 s52, s52, 196608
    s_add_u32 s40, s28, s52
    s_addc_u32 s41, s29, 0
    v_lshlrev_b32 v56, 4, v1
    s_waitcnt lgkmcnt(3)
    ds_read_b128 v[36:39], v10 offset:0
    ds_read_b128 v[40:43], v10 offset:8192
    ds_read_b128 v[44:47], v10 offset:16384
    v_mfma_f32_16x16x32_bf16 v[60:63], v[12:15], v[124:127], 0
    v_mfma_f32_16x16x32_bf16 v[64:67], v[12:15], v[132:135], 0
    v_mfma_f32_16x16x32_bf16 v[76:79], v[16:19], v[124:127], 0
    v_mfma_f32_16x16x32_bf16 v[80:83], v[16:19], v[132:135], 0
    v_mfma_f32_16x16x32_bf16 v[92:95], v[20:23], v[124:127], 0
    v_mfma_f32_16x16x32_bf16 v[96:99], v[20:23], v[132:135], 0
    v_mfma_f32_16x16x32_bf16 v[68:71], v[12:15], v[128:131], 0
    v_mfma_f32_16x16x32_bf16 v[72:75], v[12:15], v[140:143], 0
    v_mfma_f32_16x16x32_bf16 v[84:87], v[16:19], v[128:131], 0
    v_mfma_f32_16x16x32_bf16 v[88:91], v[16:19], v[140:143], 0
    v_mfma_f32_16x16x32_bf16 v[100:103], v[20:23], v[128:131], 0
    v_mfma_f32_16x16x32_bf16 v[104:107], v[20:23], v[140:143], 0
    s_add_u32 s40, s40, 4096
    s_addc_u32 s41, s41, 0
    s_waitcnt lgkmcnt(3)
    ds_read_b128 v[12:15], v11 offset:0
    ds_read_b128 v[16:19], v11 offset:8192
    ds_read_b128 v[20:23], v11 offset:16384
    v_mfma_f32_16x16x32_bf16 v[60:63], v[24:27], v[136:139], v[60:63]
    v_mfma_f32_16x16x32_bf16 v[64:67], v[24:27], v[148:151], v[64:67]
    s_setprio 3
    global_load_dwordx4 v[124:127], v56, s[40:41] offset:-4096 sc1
    s_setprio 0
    v_mfma_f32_16x16x32_bf16 v[76:79], v[28:31], v[136:139], v[76:79]
    v_mfma_f32_16x16x32_bf16 v[80:83], v[28:31], v[148:151], v[80:83]
    v_mfma_f32_16x16x32_bf16 v[92:95], v[32:35], v[136:139], v[92:95]
    s_setprio 3
    global_load_dwordx4 v[132:135], v56, s[40:41] offset:-3072 sc1
    s_setprio 0
    v_mfma_f32_16x16x32_bf16 v[96:99], v[32:35], v[148:151], v[96:99]
    v_mfma_f32_16x16x32_bf16 v[68:71], v[24:27], v[144:147], v[68:71]
    v_mfma_f32_16x16x32_bf16 v[72:75], v[24:27], v[156:159], v[72:75]
    s_setprio 3
    global_load_dwordx4 v[128:131], v56, s[40:41] offset:-2048 sc1
    s_setprio 0
    v_mfma_f32_16x16x32_bf16 v[84:87], v[28:31], v[144:147], v[84:87]
    v_mfma_f32_16x16x32_bf16 v[88:91], v[28:31], v[156:159], v[88:91]
    v_mfma_f32_16x16x32_bf16 v[100:103], v[32:35], v[144:147], v[100:103]
    s_setprio 3
    global_load_dwordx4 v[140:143], v56, s[40:41] offset:-1024 sc1
    s_setprio 0
    v_mfma_f32_16x16x32_bf16 v[104:107], v[32:35], v[156:159], v[104:107]
    s_add_u32 s40, s40, 4096
    s_addc_u32 s41, s41, 0
    s_waitcnt lgkmcnt(3)
    ds_read_b128 v[24:27], v8 offset:256
    ds_read_b128 v[28:31], v8 offset:8448
    ds_read_b128 v[32:35], v8 offset:16640
    v_mfma_f32_16x16x32_bf16 v[60:63], v[36:39], v[152:155], v[60:63]
    v_mfma_f32_16x16x32_bf16 v[64:67], v[36:39], v[164:167], v[64:67]
    s_setprio 3
    global_load_dwordx4 v[136:139], v56, s[40:41] offset:-4096 sc1
    s_setprio 0
    v_mfma_f32_16x16x32_bf16 v[76:79], v[40:43], v[152:155], v[76:79]
    v_mfma_f32_16x16x32_bf16 v[80:83], v[40:43], v[164:167], v[80:83]
    v_mfma_f32_16x16x32_bf16 v[92:95], v[44:47], v[152:155], v[92:95]
    s_setprio 3
    global_load_dwordx4 v[148:151], v56, s[40:41] offset:-3072 sc1
    s_setprio 0
    v_mfma_f32_16x16x32_bf16 v[96:99], v[44:47], v[164:167], v[96:99]
    v_mfma_f32_16x16x32_bf16 v[68:71], v[36:39], v[160:163], v[68:71]
    v_mfma_f32_16x16x32_bf16 v[72:75], v[36:39], v[172:175], v[72:75]
    s_setprio 3
    global_load_dwordx4 v[144:147], v56, s[40:41] offset:-2048 sc1
    s_setprio 0
    v_mfma_f32_16x16x32_bf16 v[84:87], v[40:43], v[160:163], v[84:87]
    v_mfma_f32_16x16x32_bf16 v[88:91], v[40:43], v[172:175], v[88:91]
    v_mfma_f32_16x16x32_bf16 v[100:103], v[44:47], v[160:163], v[100:103]
    s_setprio 3
    global_load_dwordx4 v[156:159], v56, s[40:41] offset:-1024 sc1
    s_setprio 0
    v_mfma_f32_16x16x32_bf16 v[104:107], v[44:47], v[172:175], v[104:107]
    s_add_u32 s40, s40, 4096
    s_addc_u32 s41, s41, 0
    s_waitcnt lgkmcnt(3)
    ds_read_b128 v[36:39], v9 offset:256
    ds_read_b128 v[40:43], v9 offset:8448
    ds_read_b128 v[44:47], v9 offset:16640
    v_mfma_f32_16x16x32_bf16 v[60:63], v[12:15], v[168:171], v[60:63]
    v_mfma_f32_16x16x32_bf16 v[64:67], v[12:15], v[180:183], v[64:67]
    s_setprio 3
    global_load_dwordx4 v[152:155], v56, s[40:41] offset:-4096 sc1
    s_setprio 0
    v_mfma_f32_16x16x32_bf16 v[76:79], v[16:19], v[168:171], v[76:79]
    v_mfma_f32_16x16x32_bf16 v[80:83], v[16:19], v[180:183], v[80:83]
    v_mfma_f32_16x16x32_bf16 v[92:95], v[20:23], v[168:171], v[92:95]
    s_setprio 3
    global_load_dwordx4 v[164:167], v56, s[40:41] offset:-3072 sc1
    s_setprio 0
    v_mfma_f32_16x16x32_bf16 v[96:99], v[20:23], v[180:183], v[96:99]
    v_mfma_f32_16x16x32_bf16 v[68:71], v[12:15], v[176:179], v[68:71]
    v_mfma_f32_16x16x32_bf16 v[72:75], v[12:15], v[188:191], v[72:75]
    s_setprio 3
    global_load_dwordx4 v[160:163], v56, s[40:41] offset:-2048 sc1
    s_setprio 0
    v_mfma_f32_16x16x32_bf16 v[84:87], v[16:19], v[176:179], v[84:87]
    v_mfma_f32_16x16x32_bf16 v[88:91], v[16:19], v[188:191], v[88:91]
    v_mfma_f32_16x16x32_bf16 v[100:103], v[20:23], v[176:179], v[100:103]
    s_setprio 3
    global_load_dwordx4 v[172:175], v56, s[40:41] offset:-1024 sc1
    s_setprio 0
    v_mfma_f32_16x16x32_bf16 v[104:107], v[20:23], v[188:191], v[104:107]
    s_add_u32 s40, s40, 4096
    s_addc_u32 s41, s41, 0
    s_waitcnt lgkmcnt(3)
    ds_read_b128 v[12:15], v10 offset:256
    ds_read_b128 v[16:19], v10 offset:8448
    ds_read_b128 v[20:23], v10 offset:16640
    v_mfma_f32_16x16x32_bf16 v[60:63], v[24:27], v[184:187], v[60:63]
    v_mfma_f32_16x16x32_bf16 v[64:67], v[24:27], v[196:199], v[64:67]
    s_setprio 3
    global_load_dwordx4 v[168:171], v56, s[40:41] offset:-4096 sc1
    s_setprio 0
    v_mfma_f32_16x16x32_bf16 v[76:79], v[28:31], v[184:187], v[76:79]
    v_mfma_f32_16x16x32_bf16 v[80:83], v[28:31], v[196:199], v[80:83]
    v_mfma_f32_16x16x32_bf16 v[92:95], v[32:35], v[184:187], v[92:95]
    s_setprio 3
    global_load_dwordx4 v[180:183], v56, s[40:41] offset:-3072 sc1
    s_setprio 0
    v_mfma_f32_16x16x32_bf16 v[96:99], v[32:35], v[196:199], v[96:99]
    v_mfma_f32_16x16x32_bf16 v[68:71], v[24:27], v[192:195], v[68:71]
    v_mfma_f32_16x16x32_bf16 v[72:75], v[24:27], v[204:207], v[72:75]
    s_setprio 3
    global_load_dwordx4 v[176:179], v56, s[40:41] offset:-2048 sc1
    s_setprio 0
    v_mfma_f32_16x16x32_bf16 v[84:87], v[28:31], v[192:195], v[84:87]
    v_mfma_f32_16x16x32_bf16 v[88:91], v[28:31], v[204:207], v[88:91]
    v_mfma_f32_16x16x32_bf16 v[100:103], v[32:35], v[192:195], v[100:103]
    s_setprio 3
    global_load_dwordx4 v[188:191], v56, s[40:41] offset:-1024 sc1
    s_setprio 0
    v_mfma_f32_16x16x32_bf16 v[104:107], v[32:35], v[204:207], v[104:107]
    s_add_u32 s40, s40, 4096
    s_addc_u32 s41, s41, 0
    s_waitcnt lgkmcnt(3)
    ds_read_b128 v[24:27], v11 offset:256
    ds_read_b128 v[28:31], v11 offset:8448
    ds_read_b128 v[32:35], v11 offset:16640
    v_mfma_f32_16x16x32_bf16 v[60:63], v[36:39], v[200:203], v[60:63]
    v_mfma_f32_16x16x32_bf16 v[64:67], v[36:39], v[212:215], v[64:67]
    s_setprio 3
    global_load_dwordx4 v[184:187], v56, s[40:41] offset:-4096 sc1
    s_setprio 0
    v_mfma_f32_16x16x32_bf16 v[76:79], v[40:43], v[200:203], v[76:79]
    v_mfma_f32_16x16x32_bf16 v[80:83], v[40:43], v[212:215], v[80:83]
    v_mfma_f32_16x16x32_bf16 v[92:95], v[44:47], v[200:203], v[92:95]
    s_setprio 3
    global_load_dwordx4 v[196:199], v56, s[40:41] offset:-3072 sc1
    s_setprio 0
    v_mfma_f32_16x16x32_bf16 v[96:99], v[44:47], v[212:215], v[96:99]
    v_mfma_f32_16x16x32_bf16 v[68:71], v[36:39], v[208:211], v[68:71]
    v_mfma_f32_16x16x32_bf16 v[72:75], v[36:39], v[220:223], v[72:75]
    s_setprio 3
    global_load_dwordx4 v[192:195], v56, s[40:41] offset:-2048 sc1
    s_setprio 0
    v_mfma_f32_16x16x32_bf16 v[84:87], v[40:43], v[208:211], v[84:87]
    v_mfma_f32_16x16x32_bf16 v[88:91], v[40:43], v[220:223], v[88:91]
    v_mfma_f32_16x16x32_bf16 v[100:103], v[44:47], v[208:211], v[100:103]
    s_setprio 3
    global_load_dwordx4 v[204:207], v56, s[40:41] offset:-1024 sc1
    s_setprio 0
    v_mfma_f32_16x16x32_bf16 v[104:107], v[44:47], v[220:223], v[104:107]
    s_add_u32 s40, s40, 4096
    s_addc_u32 s41, s41, 0
    s_waitcnt lgkmcnt(3)
    v_mfma_f32_16x16x32_bf16 v[60:63], v[12:15], v[216:219], v[60:63]
    v_mfma_f32_16x16x32_bf16 v[64:67], v[12:15], v[228:231], v[64:67]
    s_setprio 3
    global_load_dwordx4 v[200:203], v56, s[40:41] offset:-4096 sc1
    s_setprio 0
    v_mfma_f32_16x16x32_bf16 v[76:79], v[16:19], v[216:219], v[76:79]
    v_mfma_f32_16x16x32_bf16 v[80:83], v[16:19], v[228:231], v[80:83]
    v_mfma_f32_16x16x32_bf16 v[92:95], v[20:23], v[216:219], v[92:95]
    s_setprio 3
    global_load_dwordx4 v[212:215], v56, s[40:41] offset:-3072 sc1
    s_setprio 0
    v_mfma_f32_16x16x32_bf16 v[96:99], v[20:23], v[228:231], v[96:99]
    v_mfma_f32_16x16x32_bf16 v[68:71], v[12:15], v[224:227], v[68:71]
    v_mfma_f32_16x16x32_bf16 v[72:75], v[12:15], v[236:239], v[72:75]
    s_setprio 3
    global_load_dwordx4 v[208:211], v56, s[40:41] offset:-2048 sc1
    s_setprio 0
    v_mfma_f32_16x16x32_bf16 v[84:87], v[16:19], v[224:227], v[84:87]
    v_mfma_f32_16x16x32_bf16 v[88:91], v[16:19], v[236:239], v[88:91]
    v_mfma_f32_16x16x32_bf16 v[100:103], v[20:23], v[224:227], v[100:103]
    s_setprio 3
    global_load_dwordx4 v[220:223], v56, s[40:41] offset:-1024 sc1
    s_setprio 0
    v_mfma_f32_16x16x32_bf16 v[104:107], v[20:23], v[236:239], v[104:107]
    s_add_u32 s40, s40, 4096
    s_addc_u32 s41, s41, 0
    s_waitcnt lgkmcnt(0)
    v_mfma_f32_16x16x32_bf16 v[60:63], v[24:27], v[232:235], v[60:63]
    v_mfma_f32_16x16x32_bf16 v[64:67], v[24:27], v[244:247], v[64:67]
    s_setprio 3
    global_load_dwordx4 v[216:219], v56, s[40:41] offset:-4096 sc1
    s_setprio 0
    v_mfma_f32_16x16x32_bf16 v[76:79], v[28:31], v[232:235], v[76:79]
    v_mfma_f32_16x16x32_bf16 v[80:83], v[28:31], v[244:247], v[80:83]
    v_mfma_f32_16x16x32_bf16 v[92:95], v[32:35], v[232:235], v[92:95]
    s_setprio 3
    global_load_dwordx4 v[228:231], v56, s[40:41] offset:-3072 sc1
    s_setprio 0
    v_mfma_f32_16x16x32_bf16 v[96:99], v[32:35], v[244:247], v[96:99]
    v_mfma_f32_16x16x32_bf16 v[68:71], v[24:27], v[240:243], v[68:71]
    v_mfma_f32_16x16x32_bf16 v[72:75], v[24:27], v[252:255], v[72:75]
    s_setprio 3
    global_load_dwordx4 v[224:227], v56, s[40:41] offset:-2048 sc1
    s_setprio 0
    v_mfma_f32_16x16x32_bf16 v[84:87], v[28:31], v[240:243], v[84:87]
    v_mfma_f32_16x16x32_bf16 v[88:91], v[28:31], v[252:255], v[88:91]
    v_mfma_f32_16x16x32_bf16 v[100:103], v[32:35], v[240:243], v[100:103]
    s_setprio 3
    global_load_dwordx4 v[236:239], v56, s[40:41] offset:-1024 sc1
    s_setprio 0
    v_mfma_f32_16x16x32_bf16 v[104:107], v[32:35], v[252:255], v[104:107]
    s_setprio 3
    global_load_dwordx4 v[232:235], v56, s[40:41] offset:0 sc1
    s_setprio 0
    s_setprio 3
    global_load_dwordx4 v[244:247], v56, s[40:41] offset:1024 sc1
    s_setprio 0
    s_setprio 3
    global_load_dwordx4 v[240:243], v56, s[40:41] offset:2048 sc1
    s_setprio 0
    s_setprio 3
    global_load_dwordx4 v[252:255], v56, s[40:41] offset:3072 sc1
    s_setprio 0
    s_add_u32 s30, s44, 8192
    s_addc_u32 s31, s45, 0
    s_add_u32 s40, s44, 16384
    s_addc_u32 s41, s45, 0
    s_mov_b64 exec, 1
L_sw_6:
    ds_read_b32 v58, v1 offset:43020
    s_waitcnt lgkmcnt(0)
    v_readfirstlane_b32 s55, v58
    s_cmp_ge_u32 s55, 4
    s_cbranch_scc1 L_sw_6_d
    s_sleep 1
    s_branch L_sw_6
L_sw_6_d:
    s_mov_b64 exec, -1
    ds_read_b128 v[108:111], v8 offset:20480
    ds_read_b128 v[112:115], v9 offset:20480
    ds_read_b128 v[116:119], v10 offset:20480
    ds_read_b128 v[120:123], v11 offset:20480
    s_waitcnt lgkmcnt(3)
    s_waitcnt vmcnt(28)
    v_mfma_f32_16x16x32_bf16 v[60:63], v[108:111], v[124:127], v[60:63]
    v_mfma_f32_16x16x32_bf16 v[64:67], v[108:111], v[132:135], v[64:67]
    v_mfma_f32_16x16x32_bf16 v[68:71], v[108:111], v[128:131], v[68:71]
    v_mfma_f32_16x16x32_bf16 v[72:75], v[108:111], v[140:143], v[72:75]
    ds_read_b128 v[108:111], v8 offset:20736
    s_waitcnt lgkmcnt(3)
    s_waitcnt vmcnt(24)
    v_mfma_f32_16x16x32_bf16 v[60:63], v[112:115], v[136:139], v[60:63]
    v_mfma_f32_16x16x32_bf16 v[64:67], v[112:115], v[148:151], v[64:67]
    v_mfma_f32_16x16x32_bf16 v[68:71], v[112:115], v[144:147], v[68:71]
    v_mfma_f32_16x16x32_bf16 v[72:75], v[112:115], v[156:159], v[72:75]
    ds_read_b128 v[112:115], v9 offset:20736
    s_waitcnt lgkmcnt(3)
    s_waitcnt vmcnt(20)
    v_mfma_f32_16x16x32_bf16 v[60:63], v[116:119], v[152:155], v[60:63]
    v_mfma_f32_16x16x32_bf16 v[64:67], v[116:119], v[164:167], v[64:67]
    v_mfma_f32_16x16x32_bf16 v[68:71], v[116:119], v[160:163], v[68:71]
    v_mfma_f32_16x16x32_bf16 v[72:75], v[116:119], v[172:175], v[72:75]
    ds_read_b128 v[116:119], v10 offset:20736
    s_waitcnt lgkmcnt(3)
    s_waitcnt vmcnt(16)
    v_mfma_f32_16x16x32_bf16 v[60:63], v[120:123], v[168:171], v[60:63]
    v_mfma_f32_16x16x32_bf16 v[64:67], v[120:123], v[180:183], v[64:67]
    v_mfma_f32_16x16x32_bf16 v[68:71], v[120:123], v[176:179], v[68:71]
    v_mfma_f32_16x16x32_bf16 v[72:75], v[120:123], v[188:191], v[72:75]
    ds_read_b128 v[120:123], v11 offset:20736
    s_waitcnt lgkmcnt(3)
    s_waitcnt vmcnt(12)
    v_mfma_f32_16x16x32_bf16 v[60:63], v[108:111], v[184:187], v[60:63]
    v_mfma_f32_16x16x32_bf16 v[64:67], v[108:111], v[196:199], v[64:67]
    v_mfma_f32_16x16x32_bf16 v[68:71], v[108:111], v[192:195], v[68:71]
    v_mfma_f32_16x16x32_bf16 v[72:75], v[108:111], v[204:207], v[72:75]
    s_waitcnt lgkmcnt(2)
    s_waitcnt vmcnt(8)
    v_mfma_f32_16x16x32_bf16 v[60:63], v[112:115], v[200:203], v[60:63]
    v_mfma_f32_16x16x32_bf16 v[64:67], v[112:115], v[212:215], v[64:67]
    v_mfma_f32_16x16x32_bf16 v[68:71], v[112:115], v[208:211], v[68:71]
    v_mfma_f32_16x16x32_bf16 v[72:75], v[112:115], v[220:223], v[72:75]
    s_waitcnt lgkmcnt(1)
    s_waitcnt vmcnt(4)
    v_mfma_f32_16x16x32_bf16 v[60:63], v[116:119], v[216:219], v[60:63]
    v_mfma_f32_16x16x32_bf16 v[64:67], v[116:119], v[228:231], v[64:67]
    v_mfma_f32_16x16x32_bf16 v[68:71], v[116:119], v[224:227], v[68:71]
    v_mfma_f32_16x16x32_bf16 v[72:75], v[116:119], v[236:239], v[72:75]
    s_waitcnt lgkmcnt(0)
    s_waitcnt vmcnt(0)
    v_mfma_f32_16x16x32_bf16 v[60:63], v[120:123], v[232:235], v[60:63]
    v_mfma_f32_16x16x32_bf16 v[64:67], v[120:123], v[244:247], v[64:67]
    v_mfma_f32_16x16x32_bf16 v[68:71], v[120:123], v[240:243], v[68:71]
    v_mfma_f32_16x16x32_bf16 v[72:75], v[120:123], v[252:255], v[72:75]
    s_nop 7
    v_cvt_pk_bf16_f32 v12, v60, v64
    global_store_dword v59, v12, s[44:45] offset:0 sc1
    v_cvt_pk_bf16_f32 v13, v61, v65
    global_store_dword v59, v13, s[44:45] offset:512 sc1
    v_cvt_pk_bf16_f32 v14, v62, v66
    global_store_dword v59, v14, s[44:45] offset:1024 sc1
    v_cvt_pk_bf16_f32 v15, v63, v67
    global_store_dword v59, v15, s[44:45] offset:1536 sc1
    v_cvt_pk_bf16_f32 v16, v68, v72
    global_store_dword v59, v16, s[44:45] offset:64 sc1
    v_cvt_pk_bf16_f32 v17, v69, v73
    global_store_dword v59, v17, s[44:45] offset:576 sc1
    v_cvt_pk_bf16_f32 v18, v70, v74
    global_store_dword v59, v18, s[44:45] offset:1088 sc1
    v_cvt_pk_bf16_f32 v19, v71, v75
    global_store_dword v59, v19, s[44:45] offset:1600 sc1
    s_mov_b64 exec, 1
L_sw_7:
    ds_read_b32 v58, v1 offset:43024
    s_waitcnt lgkmcnt(0)
    v_readfirstlane_b32 s55, v58
    s_cmp_ge_u32 s55, 4
    s_cbranch_scc1 L_sw_7_d
    s_sleep 1
    s_branch L_sw_7
L_sw_7_d:
    s_mov_b64 exec, -1
    ds_read_b128 v[108:111], v8 offset:28672
    ds_read_b128 v[112:115], v9 offset:28672
    ds_read_b128 v[116:119], v10 offset:28672
    ds_read_b128 v[120:123], v11 offset:28672
    s_waitcnt lgkmcnt(3)
    v_mfma_f32_16x16x32_bf16 v[76:79], v[108:111], v[124:127], v[76:79]
    v_mfma_f32_16x16x32_bf16 v[80:83], v[108:111], v[132:135], v[80:83]
    v_mfma_f32_16x16x32_bf16 v[84:87], v[108:111], v[128:131], v[84:87]
    v_mfma_f32_16x16x32_bf16 v[88:91], v[108:111], v[140:143], v[88:91]
    ds_read_b128 v[108:111], v8 offset:28928
    s_waitcnt lgkmcnt(3)
    v_mfma_f32_16x16x32_bf16 v[76:79], v[112:115], v[136:139], v[76:79]
    v_mfma_f32_16x16x32_bf16 v[80:83], v[112:115], v[148:151], v[80:83]
    v_mfma_f32_16x16x32_bf16 v[84:87], v[112:115], v[144:147], v[84:87]
    v_mfma_f32_16x16x32_bf16 v[88:91], v[112:115], v[156:159], v[88:91]
    ds_read_b128 v[112:115], v9 offset:28928
    s_waitcnt lgkmcnt(3)
    v_mfma_f32_16x16x32_bf16 v[76:79], v[116:119], v[152:155], v[76:79]
    v_mfma_f32_16x16x32_bf16 v[80:83], v[116:119], v[164:167], v[80:83]
    v_mfma_f32_16x16x32_bf16 v[84:87], v[116:119], v[160:163], v[84:87]
    v_mfma_f32_16x16x32_bf16 v[88:91], v[116:119], v[172:175], v[88:91]
    ds_read_b128 v[116:119], v10 offset:28928
    s_waitcnt lgkmcnt(3)
    v_mfma_f32_16x16x32_bf16 v[76:79], v[120:123], v[168:171], v[76:79]
    v_mfma_f32_16x16x32_bf16 v[80:83], v[120:123], v[180:183], v[80:83]
    v_mfma_f32_16x16x32_bf16 v[84:87], v[120:123], v[176:179], v[84:87]
    v_mfma_f32_16x16x32_bf16 v[88:91], v[120:123], v[188:191], v[88:91]
    ds_read_b128 v[120:123], v11 offset:28928
    s_waitcnt lgkmcnt(3)
    v_mfma_f32_16x16x32_bf16 v[76:79], v[108:111], v[184:187], v[76:79]
    v_mfma_f32_16x16x32_bf16 v[80:83], v[108:111], v[196:199], v[80:83]
    v_mfma_f32_16x16x32_bf16 v[84:87], v[108:111], v[192:195], v[84:87]
    v_mfma_f32_16x16x32_bf16 v[88:91], v[108:111], v[204:207], v[88:91]
    s_waitcnt lgkmcnt(2)
    v_mfma_f32_16x16x32_bf16 v[76:79], v[112:115], v[200:203], v[76:79]
    v_mfma_f32_16x16x32_bf16 v[80:83], v[112:115], v[212:215], v[80:83]
    v_mfma_f32_16x16x32_bf16 v[84:87], v[112:115], v[208:211], v[84:87]
    v_mfma_f32_16x16x32_bf16 v[88:91], v[112:115], v[220:223], v[88:91]
    s_waitcnt lgkmcnt(1)
    v_mfma_f32_16x16x32_bf16 v[76:79], v[116:119], v[216:219], v[76:79]
    v_mfma_f32_16x16x32_bf16 v[80:83], v[116:119], v[228:231], v[80:83]
    v_mfma_f32_16x16x32_bf16 v[84:87], v[116:119], v[224:227], v[84:87]
    v_mfma_f32_16x16x32_bf16 v[88:91], v[116:119], v[236:239], v[88:91]
    s_waitcnt lgkmcnt(0)
    v_mfma_f32_16x16x32_bf16 v[76:79], v[120:123], v[232:235], v[76:79]
    v_mfma_f32_16x16x32_bf16 v[80:83], v[120:123], v[244:247], v[80:83]
    v_mfma_f32_16x16x32_bf16 v[84:87], v[120:123], v[240:243], v[84:87]
    v_mfma_f32_16x16x32_bf16 v[88:91], v[120:123], v[252:255], v[88:91]
    s_nop 7
    v_cvt_pk_bf16_f32 v20, v76, v80
    global_store_dword v59, v20, s[30:31] offset:0 sc1
    v_cvt_pk_bf16_f32 v21, v77, v81
    global_store_dword v59, v21, s[30:31] offset:512 sc1
    v_cvt_pk_bf16_f32 v22, v78, v82
    global_store_dword v59, v22, s[30:31] offset:1024 sc1
    v_cvt_pk_bf16_f32 v23, v79, v83
    global_store_dword v59, v23, s[30:31] offset:1536 sc1
    v_cvt_pk_bf16_f32 v24, v84, v88
    global_store_dword v59, v24, s[30:31] offset:64 sc1
    v_cvt_pk_bf16_f32 v25, v85, v89
    global_store_dword v59, v25, s[30:31] offset:576 sc1
    v_cvt_pk_bf16_f32 v26, v86, v90
    global_store_dword v59, v26, s[30:31] offset:1088 sc1
    v_cvt_pk_bf16_f32 v27, v87, v91
    global_store_dword v59, v27, s[30:31] offset:1600 sc1
    s_mov_b64 exec, 1
L_sw_8:
    ds_read_b32 v58, v1 offset:43028
    s_waitcnt lgkmcnt(0)
    v_readfirstlane_b32 s55, v58
    s_cmp_ge_u32 s55, 4
    s_cbranch_scc1 L_sw_8_d
    s_sleep 1
    s_branch L_sw_8
L_sw_8_d:
    s_mov_b64 exec, -1
    ds_read_b128 v[108:111], v8 offset:36864
    ds_read_b128 v[112:115], v9 offset:36864
    ds_read_b128 v[116:119], v10 offset:36864
    ds_read_b128 v[120:123], v11 offset:36864
    s_waitcnt lgkmcnt(3)
    v_mfma_f32_16x16x32_bf16 v[92:95], v[108:111], v[124:127], v[92:95]
    v_mfma_f32_16x16x32_bf16 v[96:99], v[108:111], v[132:135], v[96:99]
    v_mfma_f32_16x16x32_bf16 v[100:103], v[108:111], v[128:131], v[100:103]
    v_mfma_f32_16x16x32_bf16 v[104:107], v[108:111], v[140:143], v[104:107]
    ds_read_b128 v[108:111], v8 offset:37120
    s_waitcnt lgkmcnt(3)
    v_mfma_f32_16x16x32_bf16 v[92:95], v[112:115], v[136:139], v[92:95]
    v_mfma_f32_16x16x32_bf16 v[96:99], v[112:115], v[148:151], v[96:99]
    v_mfma_f32_16x16x32_bf16 v[100:103], v[112:115], v[144:147], v[100:103]
    v_mfma_f32_16x16x32_bf16 v[104:107], v[112:115], v[156:159], v[104:107]
    ds_read_b128 v[112:115], v9 offset:37120
    s_waitcnt lgkmcnt(3)
    v_mfma_f32_16x16x32_bf16 v[92:95], v[116:119], v[152:155], v[92:95]
    v_mfma_f32_16x16x32_bf16 v[96:99], v[116:119], v[164:167], v[96:99]
    v_mfma_f32_16x16x32_bf16 v[100:103], v[116:119], v[160:163], v[100:103]
    v_mfma_f32_16x16x32_bf16 v[104:107], v[116:119], v[172:175], v[104:107]
    ds_read_b128 v[116:119], v10 offset:37120
    s_waitcnt lgkmcnt(3)
    v_mfma_f32_16x16x32_bf16 v[92:95], v[120:123], v[168:171], v[92:95]
    v_mfma_f32_16x16x32_bf16 v[96:99], v[120:123], v[180:183], v[96:99]
    v_mfma_f32_16x16x32_bf16 v[100:103], v[120:123], v[176:179], v[100:103]
    v_mfma_f32_16x16x32_bf16 v[104:107], v[120:123], v[188:191], v[104:107]
    ds_read_b128 v[120:123], v11 offset:37120
    s_waitcnt lgkmcnt(3)
    v_mfma_f32_16x16x32_bf16 v[92:95], v[108:111], v[184:187], v[92:95]
    v_mfma_f32_16x16x32_bf16 v[96:99], v[108:111], v[196:199], v[96:99]
    v_mfma_f32_16x16x32_bf16 v[100:103], v[108:111], v[192:195], v[100:103]
    v_mfma_f32_16x16x32_bf16 v[104:107], v[108:111], v[204:207], v[104:107]
    s_waitcnt lgkmcnt(2)
    v_mfma_f32_16x16x32_bf16 v[92:95], v[112:115], v[200:203], v[92:95]
    v_mfma_f32_16x16x32_bf16 v[96:99], v[112:115], v[212:215], v[96:99]
    v_mfma_f32_16x16x32_bf16 v[100:103], v[112:115], v[208:211], v[100:103]
    v_mfma_f32_16x16x32_bf16 v[104:107], v[112:115], v[220:223], v[104:107]
    s_waitcnt lgkmcnt(1)
    v_mfma_f32_16x16x32_bf16 v[92:95], v[116:119], v[216:219], v[92:95]
    v_mfma_f32_16x16x32_bf16 v[96:99], v[116:119], v[228:231], v[96:99]
    v_mfma_f32_16x16x32_bf16 v[100:103], v[116:119], v[224:227], v[100:103]
    v_mfma_f32_16x16x32_bf16 v[104:107], v[116:119], v[236:239], v[104:107]
    s_waitcnt lgkmcnt(0)
    v_mfma_f32_16x16x32_bf16 v[92:95], v[120:123], v[232:235], v[92:95]
    v_mfma_f32_16x16x32_bf16 v[96:99], v[120:123], v[244:247], v[96:99]
    v_mfma_f32_16x16x32_bf16 v[100:103], v[120:123], v[240:243], v[100:103]
    v_mfma_f32_16x16x32_bf16 v[104:107], v[120:123], v[252:255], v[104:107]
    s_nop 7
    s_mov_b32 exec_hi, 0
    v_cvt_pk_bf16_f32 v12, v92, v96
    global_store_dword v59, v12, s[40:41] offset:0 sc1
    v_cvt_pk_bf16_f32 v13, v93, v97
    global_store_dword v59, v13, s[40:41] offset:512 sc1
    v_cvt_pk_bf16_f32 v14, v94, v98
    global_store_dword v59, v14, s[40:41] offset:1024 sc1
    v_cvt_pk_bf16_f32 v15, v95, v99
    global_store_dword v59, v15, s[40:41] offset:1536 sc1
    v_cvt_pk_bf16_f32 v16, v100, v104
    global_store_dword v59, v16, s[40:41] offset:64 sc1
    v_cvt_pk_bf16_f32 v17, v101, v105
    global_store_dword v59, v17, s[40:41] offset:576 sc1
    v_cvt_pk_bf16_f32 v18, v102, v106
    global_store_dword v59, v18, s[40:41] offset:1088 sc1
    v_cvt_pk_bf16_f32 v19, v103, v107
    global_store_dword v59, v19, s[40:41] offset:1600 sc1
    s_mov_b64 exec, -1
    s_branch L_fin
L_B:
    s_mul_i32 s52, s2, 2500
    s_lshl_b32 s53, s51, 8
    s_add_u32 s52, s52, s53
    v_lshl_add_u32 v52, v1, 2, s52
    s_lshl_b32 s53, s51, 6
    v_add_u32 v53, s53, v1
    v_cmp_gt_u32 vcc, 0x71, v53
    s_mov_b64 s[58:59], vcc
    v_lshrrev_b32 v54, 2, v1
    v_add_u32 v54, s53, v54
    v_lshlrev_b32 v54, 14, v54
    v_and_b32 v55, 3, v1
    v_lshl_or_b32 v54, v55, 4, v54
    s_lshl_b32 s52, s2, 6
    v_add_u32 v54, s52, v54
    s_lshl_b32 s52, s51, 12
    v_lshl_add_u32 v57, v1, 4, s52
    s_mov_b32 s46, 4096000
    s_mov_b32 s38, 81440
    s_movk_i32 s55, -40
    s_waitcnt lgkmcnt(0)
    s_setprio 2
    global_load_dword v4, v34, s[10:11]
    global_load_dword v12, v52, s[8:9] offset:0
    global_load_dword v16, v52, s[6:7] offset:0
    global_load_dword v13, v52, s[8:9] offset:1024
    global_load_dword v17, v52, s[6:7] offset:1024
    s_mov_b64 exec, s[58:59]
    global_load_dword v14, v52, s[8:9] offset:2048
    global_load_dword v18, v52, s[6:7] offset:2048
    s_cmp_eq_u32 s3, 4
    s_cselect_b64 exec, 1, 0
    global_load_dword v50, v1, s[28:29] offset:0 sc1
    s_mov_b64 exec, -1
    s_barrier
    s_add_u32 s44, s28, 327680
    s_addc_u32 s45, s29, 0
    s_mov_b32 s32, s4
    s_mov_b32 s33, s5
    s_sub_u32 s36, s14, 61440
    s_subb_u32 s37, s15, 0
    s_mov_b32 s40, s16
    s_mov_b32 s41, s17
    s_mul_i32 s10, s51, 20480
    s_add_u32 s10, s10, 81920
    s_waitcnt vmcnt(6)
    v_mul_u32_u24 v20, 52429, v12
    v_lshrrev_b32 v20, 21, v20
    v_lshlrev_b32 v58, 2, v20
    ds_add_rtn_u32 v24, v58, v0 offset:40960
    v_mad_i32_i24 v12, v20, s55, v12
    v_lshlrev_b32 v20, 6, v20
    s_waitcnt vmcnt(5)
    v_lshl_add_u32 v16, v12, 14, v16
    v_add_u32 v16, 0x4001, v16
    s_waitcnt vmcnt(4)
    v_mul_u32_u24 v21, 52429, v13
    v_lshrrev_b32 v21, 21, v21
    v_lshlrev_b32 v58, 2, v21
    ds_add_rtn_u32 v25, v58, v0 offset:40960
    v_mad_i32_i24 v13, v21, s55, v13
    v_lshlrev_b32 v21, 6, v21
    s_waitcnt vmcnt(3)
    v_lshl_add_u32 v17, v13, 14, v17
    v_add_u32 v17, 0x4001, v17
    s_waitcnt vmcnt(2)
    v_mul_u32_u24 v22, 52429, v14
    v_lshrrev_b32 v22, 21, v22
    v_lshlrev_b32 v58, 2, v22
    s_mov_b64 exec, s[58:59]
    ds_add_rtn_u32 v26, v58, v0 offset:40960
    s_mov_b64 exec, -1
    v_mad_i32_i24 v14, v22, s55, v14
    v_lshlrev_b32 v22, 6, v22
    s_waitcnt vmcnt(1)
    v_lshl_add_u32 v18, v14, 14, v18
    v_add_u32 v18, 0x4001, v18
    s_waitcnt vmcnt(0)
    v_lshl_or_b32 v4, v4, 9, v33
    v_readfirstlane_b32 s0, v50
    s_waitcnt lgkmcnt(0)
    s_lshr_b32 s0, s0, 20
    s_add_u32 s0, s0, 1
    s_lshl_b32 s0, s0, 20
    s_or_b32 s0, s0, 1
    v_cndmask_b32 v26, 0, v26, s[58:59]
    v_mov_b32 v56, s0
    v_max3_u32 v58, v24, v25, v26
    v_cmp_lt_u32 vcc, 15, v58
    s_cmp_eq_u32 s3, 4
    s_cselect_b64 exec, 1, 0
    ds_write_b32 v1, v56 offset:43072
    s_mov_b64 exec, -1
    v_lshl_add_u32 v12, v24, 2, v20
    v_lshl_add_u32 v13, v25, 2, v21
    v_lshl_add_u32 v14, v26, 2, v22
    s_cbranch_vccz L_nopo
    v_mov_b32 v58, 1032192
    v_cmp_lt_u32 vcc, 15, v24
    v_min_u32 v59, 15, v24
    v_lshl_add_u32 v12, v59, 2, v20
    v_cndmask_b32 v16, v16, v58, vcc
    v_cmp_lt_u32 vcc, 15, v25
    v_min_u32 v59, 15, v25
    v_lshl_add_u32 v13, v59, 2, v21
    v_cndmask_b32 v17, v17, v58, vcc
    v_cmp_lt_u32 vcc, 15, v26
    v_min_u32 v59, 15, v26
    v_lshl_add_u32 v14, v59, 2, v22
    v_cndmask_b32 v18, v18, v58, vcc
L_nopo:
    ds_or_b32 v12, v16 offset:45056
    ds_or_b32 v13, v17 offset:45056
    s_mov_b64 exec, s[58:59]
    ds_or_b32 v14, v18 offset:45056
    s_mov_b64 exec, -1
    v_mov_b64 v[12:13], 0
    v_mov_b64 v[14:15], 0
    s_mov_b32 s52, 0x40000
    s_mov_b32 s53, 0x80000
    s_mov_b32 s55, 0xc0000
    s_waitcnt lgkmcnt(0)
    s_mov_b64 exec, 1
    ds_add_u32 v1, v0 offset:43048
    s_mov_b64 exec, -1
    s_mov_b64 exec, 1
L_sw_9:
    ds_read_b32 v56, v1 offset:43048
    s_waitcnt lgkmcnt(0)
    v_readfirstlane_b32 s54, v56
    s_cmp_ge_u32 s54, 4
    s_cbranch_scc1 L_sw_9_d
    s_nop 0
    s_branch L_sw_9
L_sw_9_d:
    s_mov_b64 exec, -1
    ds_read_b32 v56, v1 offset:43072
    ds_read_b128 v[60:63], v57 offset:45056
    ds_read_b128 v[64:67], v57 offset:46080
    ds_read_b128 v[68:71], v57 offset:47104
    ds_read_b128 v[72:75], v57 offset:48128
    s_waitcnt lgkmcnt(4)
    v_readfirstlane_b32 s0, v56
    s_and_b32 s60, s0, 0xfff00000
    s_mov_b32 s61, s60
    s_waitcnt lgkmcnt(3)
    v_lshl_add_u64 v[60:61], v[60:61], 0, s[60:61]
    v_lshl_add_u64 v[62:63], v[62:63], 0, s[60:61]
    buffer_store_dwordx4 v[60:63], v54, s[44:47], 0 offen sc1
    s_waitcnt lgkmcnt(2)
    v_lshl_add_u64 v[64:65], v[64:65], 0, s[60:61]
    v_lshl_add_u64 v[66:67], v[66:67], 0, s[60:61]
    buffer_store_dwordx4 v[64:67], v54, s[44:47], s52 offen sc1
    s_waitcnt lgkmcnt(1)
    v_lshl_add_u64 v[68:69], v[68:69], 0, s[60:61]
    v_lshl_add_u64 v[70:71], v[70:71], 0, s[60:61]
    buffer_store_dwordx4 v[68:71], v54, s[44:47], s53 offen sc1
    s_waitcnt lgkmcnt(0)
    v_lshl_add_u64 v[72:73], v[72:73], 0, s[60:61]
    v_lshl_add_u64 v[74:75], v[74:75], 0, s[60:61]
    buffer_store_dwordx4 v[72:75], v54, s[44:47], s55 offen sc1
    s_setprio 0
    ds_write_b128 v57, v[12:15] offset:45056
    ds_write_b128 v57, v[12:15] offset:46080
    ds_write_b128 v57, v[12:15] offset:47104
    ds_write_b128 v57, v[12:15] offset:48128
    s_mov_b64 exec, 1
    ds_add_u32 v1, v0 offset:43056
    s_mov_b64 exec, -1
    s_cmp_lg_u32 s3, 7
    s_cbranch_scc1 L_Bn
    s_cmp_ge_u32 s2, 250
    s_cbranch_scc1 L_Bm0
L_Bm0:
    s_setprio 2
    v_mov_b32 v43, s0
    s_mov_b64 exec, 1
L_sw_10:
    ds_read_b32 v44, v1 offset:43032
    s_waitcnt lgkmcnt(0)
    v_readfirstlane_b32 s52, v44
    s_cmp_ge_u32 s52, 4
    s_cbranch_scc1 L_sw_10_d
    s_sleep 1
    s_branch L_sw_10
L_sw_10_d:
    s_mov_b64 exec, -1
    v_lshlrev_b32 v40, 10, v29
    v_lshl_add_u32 v40, v30, 2, v40
    s_bfe_u32 s53, s2, 0x10001
    s_lshl_b32 s53, s53, 6
    v_add_u32 v40, s53, v40
    ds_read_b32 v12, v40 offset:36864
    ds_read_b32 v13, v40 offset:36992
    ds_read_b32 v14, v40 offset:37120
    ds_read_b32 v15, v40 offset:37248
    ds_read_b32 v16, v40 offset:37376
    ds_read_b32 v17, v40 offset:37504
    ds_read_b32 v18, v40 offset:37632
    ds_read_b32 v19, v40 offset:37760
    s_bitcmp1_b32 s2, 0
    s_cselect_b32 s52, s49, s48
    s_lshl_b32 s53, s2, 10
    s_add_u32 s53, s53, 196608
    v_lshl_add_u32 v41, v1, 4, s53
    s_waitcnt lgkmcnt(0)
    v_perm_b32 v20, v13, v12, s52
    v_perm_b32 v21, v15, v14, s52
    v_perm_b32 v22, v17, v16, s52
    v_perm_b32 v23, v19, v18, s52
    s_cmp_lt_u32 s2, 128
    s_cselect_b64 exec, -1, 0
    global_store_dwordx4 v41, v[20:23], s[28:29] sc1
    s_mov_b64 exec, -1
    v_lshlrev_b32 v50, 4, v30
    v_lshrrev_b32 v51, 1, v29
    v_lshl_or_b32 v50, v51, 8, v50
    v_and_b32 v51, 1, v29
    v_lshl_or_b32 v50, v51, 3, v50
    s_lshl_b32 s52, s2, 9
    s_add_u32 s52, s52, 65536
    v_add_u32 v50, s52, v50
    ds_read_b128 v[60:63], v8 offset:20480
    ds_read_b128 v[92:95], v8 offset:28672
    ds_read_b128 v[64:67], v9 offset:20480
    ds_read_b128 v[96:99], v9 offset:28672
    ds_read_b128 v[68:71], v10 offset:20480
    ds_read_b128 v[100:103], v10 offset:28672
    ds_read_b128 v[72:75], v11 offset:20480
    ds_read_b128 v[104:107], v11 offset:28672
    s_waitcnt lgkmcnt(6)
    ds_read_b128 v[76:79], v8 offset:20736
    ds_read_b128 v[108:111], v8 offset:28928
    ds_read_b128 v[80:83], v9 offset:20736
    ds_read_b128 v[112:115], v9 offset:28928
    ds_read_b128 v[84:87], v10 offset:20736
    ds_read_b128 v[116:119], v10 offset:28928
    ds_read_b128 v[88:91], v11 offset:20736
    ds_read_b128 v[120:123], v11 offset:28928
    s_waitcnt lgkmcnt(8)
    v_mfma_f32_16x16x32_bf16 v[44:47], v[60:63], v[92:95], 0
    s_waitcnt lgkmcnt(8)
    v_mfma_f32_16x16x32_bf16 v[44:47], v[64:67], v[96:99], v[44:47]
    s_waitcnt lgkmcnt(8)
    v_mfma_f32_16x16x32_bf16 v[44:47], v[68:71], v[100:103], v[44:47]
    s_waitcnt lgkmcnt(8)
    v_mfma_f32_16x16x32_bf16 v[44:47], v[72:75], v[104:107], v[44:47]
    s_waitcnt lgkmcnt(6)
    v_mfma_f32_16x16x32_bf16 v[44:47], v[76:79], v[108:111], v[44:47]
    s_waitcnt lgkmcnt(4)
    v_mfma_f32_16x16x32_bf16 v[44:47], v[80:83], v[112:115], v[44:47]
    s_waitcnt lgkmcnt(2)
    v_mfma_f32_16x16x32_bf16 v[44:47], v[84:87], v[116:119], v[44:47]
    s_waitcnt lgkmcnt(0)
    v_mfma_f32_16x16x32_bf16 v[44:47], v[88:91], v[120:123], v[44:47]
    s_lshl_b32 s52, s2, 2
    s_add_u32 s52, s52, 4096
    v_lshl_add_u32 v42, v1, 10, s52
    s_nop 4
    v_cvt_pk_bf16_f32 v48, v44, v45
    v_cvt_pk_bf16_f32 v49, v46, v47
    global_store_dwordx2 v50, v[48:49], s[28:29] sc1
    s_mov_b64 exec, 1
    ds_add_u32 v1, v0 offset:43068
    s_mov_b64 exec, -1
    s_cmp_lt_u32 s2, 250
    s_cbranch_scc1 L_Bm1
    s_waitcnt vmcnt(0)
    s_mov_b64 exec, 0xff
    v_readfirstlane_b32 s52, v43
    s_nop 1
    v_mov_b32 v43, s52
    global_store_dword v42, v43, s[28:29] sc1
    s_mov_b64 exec, -1
    s_waitcnt lgkmcnt(0)
    s_endpgm
L_Bm1:
    v_lshlrev_b32 v58, 4, v1
    s_mul_i32 s54, s51, 5120
    s_add_u32 s54, s54, 61440
    s_lshl_b32 s55, s51, 10
    s_add_u32 m0, s54, 0
    s_nop 0
    buffer_load_dwordx4 v58, s[36:39], m0 offen  lds
    s_add_u32 m0, s54, 1024
    s_nop 0
    buffer_load_dwordx4 v58, s[36:39], m0 offen  lds
    s_add_u32 m0, s54, 2048
    s_nop 0
    buffer_load_dwordx4 v58, s[36:39], m0 offen  lds
    s_add_u32 m0, s54, 3072
    s_nop 0
    buffer_load_dwordx4 v58, s[36:39], m0 offen  lds
    s_add_u32 m0, s54, 4096
    s_nop 0
    buffer_load_dwordx4 v58, s[36:39], m0 offen  lds
    s_waitcnt vmcnt(5)
    s_mov_b64 exec, 0xff
    v_readfirstlane_b32 s52, v43
    s_nop 1
    v_mov_b32 v43, s52
    global_store_dword v42, v43, s[28:29] sc1
    s_mov_b64 exec, -1
    s_setprio 0
    s_waitcnt vmcnt(1)
    s_mov_b64 exec, 1
    ds_add_u32 v1, v0 offset:43060
    s_mov_b64 exec, -1
    s_add_u32 m0, s10, 0
    v_xor_b32_dpp v40, v4, v3 row_newbcast:0 row_mask:0xf bank_mask:0xf
    buffer_load_dwordx4 v40, s[32:35], 0 offen sc1 lds
    s_add_u32 m0, s10, 1024
    v_xor_b32_dpp v41, v4, v3 row_newbcast:1 row_mask:0xf bank_mask:0xf
    buffer_load_dwordx4 v41, s[32:35], 0 offen sc1 lds
    s_add_u32 m0, s10, 2048
    v_xor_b32_dpp v40, v4, v3 row_newbcast:2 row_mask:0xf bank_mask:0xf
    buffer_load_dwordx4 v40, s[32:35], 0 offen sc1 lds
    s_add_u32 m0, s10, 3072
    v_xor_b32_dpp v41, v4, v3 row_newbcast:3 row_mask:0xf bank_mask:0xf
    buffer_load_dwordx4 v41, s[32:35], 0 offen sc1 lds
    s_branch L_Bj
L_Bn:
    s_cmp_ge_u32 s2, 250
    s_cbranch_scc1 L_end
    v_lshlrev_b32 v58, 4, v1
    s_mul_i32 s54, s51, 5120
    s_add_u32 s54, s54, 61440
    s_lshl_b32 s55, s51, 10
    s_add_u32 m0, s54, 0
    s_nop 0
    buffer_load_dwordx4 v58, s[36:39], m0 offen  lds
    s_add_u32 m0, s54, 1024
    s_nop 0
    buffer_load_dwordx4 v58, s[36:39], m0 offen  lds
    s_add_u32 m0, s54, 2048
    s_nop 0
    buffer_load_dwordx4 v58, s[36:39], m0 offen  lds
    s_add_u32 m0, s54, 3072
    s_nop 0
    buffer_load_dwordx4 v58, s[36:39], m0 offen  lds
    s_add_u32 m0, s54, 4096
    s_nop 0
    buffer_load_dwordx4 v58, s[36:39], m0 offen  lds
    s_setprio 0
    s_mov_b64 exec, 1
L_sw_11:
    ds_read_b32 v44, v1 offset:43068
    s_waitcnt lgkmcnt(0)
    v_readfirstlane_b32 s52, v44
    s_cmp_ge_u32 s52, 1
    s_cbranch_scc1 L_sw_11_d
    s_sleep 1
    s_branch L_sw_11
L_sw_11_d:
    s_mov_b64 exec, -1
    s_add_u32 m0, s10, 0
    v_xor_b32_dpp v40, v4, v3 row_newbcast:0 row_mask:0xf bank_mask:0xf
    buffer_load_dwordx4 v40, s[32:35], 0 offen sc1 lds
    s_add_u32 m0, s10, 1024
    v_xor_b32_dpp v41, v4, v3 row_newbcast:1 row_mask:0xf bank_mask:0xf
    buffer_load_dwordx4 v41, s[32:35], 0 offen sc1 lds
    s_add_u32 m0, s10, 2048
    v_xor_b32_dpp v40, v4, v3 row_newbcast:2 row_mask:0xf bank_mask:0xf
    buffer_load_dwordx4 v40, s[32:35], 0 offen sc1 lds
    s_add_u32 m0, s10, 3072
    v_xor_b32_dpp v41, v4, v3 row_newbcast:3 row_mask:0xf bank_mask:0xf
    buffer_load_dwordx4 v41, s[32:35], 0 offen sc1 lds
    s_waitcnt vmcnt(4)
    s_mov_b64 exec, 1
    ds_add_u32 v1, v0 offset:43060
    s_mov_b64 exec, -1
L_Bj:
    s_lshl_b32 s52, s2, 14
    s_add_u32 s52, s52, 327680
    s_add_u32 s44, s28, s52
    s_addc_u32 s45, s29, 0
    s_movk_i32 s46, 16384
    s_lshl_b32 s52, s51, 10
    v_lshl_add_u32 v93, v1, 4, s52
    s_movk_i32 s53, 4096
    s_movk_i32 s54, 8192
    s_movk_i32 s55, 12288
    s_setprio 1
    buffer_load_dwordx4 v[12:15], v93, s[44:47], 0 offen sc1
    buffer_load_dwordx4 v[16:19], v93, s[44:47], s53 offen sc1
    buffer_load_dwordx4 v[20:23], v93, s[44:47], s54 offen sc1
    buffer_load_dwordx4 v[24:27], v93, s[44:47], s55 offen sc1
    v_mul_u32_u24 v94, 26, v1
    v_lshrrev_b32 v94, 8, v94
    v_mul_u32_u24 v95, 10, v94
    v_sub_u32 v95, v1, v95
    v_lshrrev_b32 v96, 2, v95
    v_lshlrev_b32 v96, 4, v96
    v_lshl_add_u32 v96, v94, 2, v96
    v_and_b32 v97, 3, v95
    v_cmp_gt_u32 vcc, 8, v95
    v_add_u32 v96, v96, v97
    v_lshl_add_u32 v97, v94, 1, v95
    v_add_u32 v97, 24, v97
    v_cndmask_b32 v96, v97, v96, vcc
    v_min_u32 v96, 47, v96
    v_lshlrev_b32 v92, 2, v96
    s_and_b32 s58, s0, 0xfff00000
    s_sub_u32 s59, 0, s58
    s_subb_u32 s58, 0, s58
    s_mov_b32 s57, s58
    s_mov_b32 s58, s59
    s_mov_b32 s59, s57
    s_mov_b32 s57, 0
    s_waitcnt vmcnt(0)
    s_branch L_slv
L_slp:
    s_waitcnt vmcnt(0)
L_slv:
    v_lshl_add_u64 v[12:13], v[12:13], 0, s[58:59]
    v_lshl_add_u64 v[14:15], v[14:15], 0, s[58:59]
    v_lshl_add_u64 v[16:17], v[16:17], 0, s[58:59]
    v_lshl_add_u64 v[18:19], v[18:19], 0, s[58:59]
    v_lshl_add_u64 v[20:21], v[20:21], 0, s[58:59]
    v_lshl_add_u64 v[22:23], v[22:23], 0, s[58:59]
    v_lshl_add_u64 v[24:25], v[24:25], 0, s[58:59]
    v_lshl_add_u64 v[26:27], v[26:27], 0, s[58:59]
    v_max3_u32 v94, v12, v13, v14
    v_max3_u32 v95, v15, v16, v17
    v_max3_u32 v94, v94, v18, v19
    v_max3_u32 v95, v95, v20, v21
    v_max3_u32 v94, v94, v22, v23
    v_max3_u32 v95, v95, v24, v25
    v_max3_u32 v94, v94, v26, v27
    v_max_u32 v94, v94, v95
    v_cmp_lt_u32 vcc, 0xfffff, v94
    s_cbranch_vccz L_slok
    s_add_u32 s57, s57, 1
    s_cmp_gt_u32 s57, 0x40000
    s_cbranch_scc1 L_giveup
    s_sleep 4
    buffer_load_dwordx4 v[12:15], v93, s[44:47], 0 offen sc1
    buffer_load_dwordx4 v[16:19], v93, s[44:47], s53 offen sc1
    buffer_load_dwordx4 v[20:23], v93, s[44:47], s54 offen sc1
    buffer_load_dwordx4 v[24:27], v93, s[44:47], s55 offen sc1
    s_branch L_slp
L_slok:
    v_cmp_lt_u32 vcc, 671743, v94
    s_movk_i32 s54, 0x3fff
    v_cmp_ne_u32 s[60:61], 0, v12
    v_bfe_u32 v28, v12, 12, 8
    v_and_b32 v28, 0xfc, v28
    s_cbranch_vccz L_noovf
    s_mov_b64 exec, 1
    ds_write_b32 v1, v0 offset:43076
    s_mov_b64 exec, -1
    s_waitcnt lgkmcnt(0)
L_noovf:
    v_cmp_ne_u32 s[62:63], 0, v13
    v_bfe_u32 v29, v13, 12, 8
    v_and_b32 v29, 0xfc, v29
    v_cmp_ne_u32 s[64:65], 0, v14
    v_bfe_u32 v30, v14, 12, 8
    v_and_b32 v30, 0xfc, v30
    v_cmp_ne_u32 s[66:67], 0, v15
    v_bfe_u32 v31, v15, 12, 8
    v_and_b32 v31, 0xfc, v31
    v_cmp_ne_u32 s[68:69], 0, v16
    v_bfe_u32 v32, v16, 12, 8
    v_and_b32 v32, 0xfc, v32
    v_cmp_ne_u32 s[70:71], 0, v17
    v_bfe_u32 v33, v17, 12, 8
    v_and_b32 v33, 0xfc, v33
    v_cmp_ne_u32 s[72:73], 0, v18
    v_bfe_u32 v34, v18, 12, 8
    v_and_b32 v34, 0xfc, v34
    v_cmp_ne_u32 s[74:75], 0, v19
    v_bfe_u32 v35, v19, 12, 8
    v_and_b32 v35, 0xfc, v35
    v_cmp_ne_u32 s[16:17], 0, v20
    v_bfe_u32 v36, v20, 12, 8
    v_and_b32 v36, 0xfc, v36
    v_cmp_ne_u32 s[18:19], 0, v21
    v_bfe_u32 v37, v21, 12, 8
    v_and_b32 v37, 0xfc, v37
    v_cmp_ne_u32 s[20:21], 0, v22
    v_bfe_u32 v38, v22, 12, 8
    v_and_b32 v38, 0xfc, v38
    v_cmp_ne_u32 s[22:23], 0, v23
    v_bfe_u32 v39, v23, 12, 8
    v_and_b32 v39, 0xfc, v39
    v_cmp_ne_u32 s[24:25], 0, v24
    v_bfe_u32 v40, v24, 12, 8
    v_and_b32 v40, 0xfc, v40
    v_cmp_ne_u32 s[26:27], 0, v25
    v_bfe_u32 v41, v25, 12, 8
    v_and_b32 v41, 0xfc, v41
    v_cmp_ne_u32 s[40:41], 0, v26
    v_bfe_u32 v42, v26, 12, 8
    v_and_b32 v42, 0xfc, v42
    v_cmp_ne_u32 s[42:43], 0, v27
    v_bfe_u32 v43, v27, 12, 8
    v_and_b32 v43, 0xfc, v43
    s_mov_b64 exec, s[60:61]
    ds_add_rtn_u32 v44, v28, v0 offset:41984
    s_mov_b64 exec, s[62:63]
    ds_add_rtn_u32 v45, v29, v0 offset:41984
    s_mov_b64 exec, s[64:65]
    ds_add_rtn_u32 v46, v30, v0 offset:41984
    s_mov_b64 exec, s[66:67]
    ds_add_rtn_u32 v47, v31, v0 offset:41984
    s_mov_b64 exec, s[68:69]
    ds_add_rtn_u32 v48, v32, v0 offset:41984
    s_mov_b64 exec, s[70:71]
    ds_add_rtn_u32 v49, v33, v0 offset:41984
    s_mov_b64 exec, s[72:73]
    ds_add_rtn_u32 v50, v34, v0 offset:41984
    s_mov_b64 exec, s[74:75]
    ds_add_rtn_u32 v51, v35, v0 offset:41984
    s_mov_b64 exec, s[16:17]
    ds_add_rtn_u32 v52, v36, v0 offset:41984
    s_mov_b64 exec, s[18:19]
    ds_add_rtn_u32 v53, v37, v0 offset:41984
    s_mov_b64 exec, s[20:21]
    ds_add_rtn_u32 v54, v38, v0 offset:41984
    s_mov_b64 exec, s[22:23]
    ds_add_rtn_u32 v55, v39, v0 offset:41984
    s_mov_b64 exec, s[24:25]
    ds_add_rtn_u32 v56, v40, v0 offset:41984
    s_mov_b64 exec, s[26:27]
    ds_add_rtn_u32 v57, v41, v0 offset:41984
    s_mov_b64 exec, s[40:41]
    ds_add_rtn_u32 v58, v42, v0 offset:41984
    s_waitcnt lgkmcnt(14)
    s_mov_b64 exec, s[42:43]
    ds_add_rtn_u32 v59, v43, v0 offset:41984
    s_mov_b64 exec, -1
    s_add_u32 m0, s10, 4096
    v_xor_b32_dpp v101, v4, v3 row_newbcast:4 row_mask:0xf bank_mask:0xf
    buffer_load_dwordx4 v101, s[32:35], 0 offen sc1 lds
    s_add_u32 m0, s10, 5120
    v_xor_b32_dpp v102, v4, v3 row_newbcast:5 row_mask:0xf bank_mask:0xf
    buffer_load_dwordx4 v102, s[32:35], 0 offen sc1 lds
    s_add_u32 m0, s10, 6144
    v_xor_b32_dpp v101, v4, v3 row_newbcast:6 row_mask:0xf bank_mask:0xf
    buffer_load_dwordx4 v101, s[32:35], 0 offen sc1 lds
    s_add_u32 m0, s10, 7168
    v_xor_b32_dpp v102, v4, v3 row_newbcast:7 row_mask:0xf bank_mask:0xf
    buffer_load_dwordx4 v102, s[32:35], 0 offen sc1 lds
    s_add_u32 m0, s10, 8192
    v_xor_b32_dpp v101, v4, v3 row_newbcast:8 row_mask:0xf bank_mask:0xf
    buffer_load_dwordx4 v101, s[32:35], 0 offen sc1 lds
    s_add_u32 m0, s10, 9216
    v_xor_b32_dpp v102, v4, v3 row_newbcast:9 row_mask:0xf bank_mask:0xf
    buffer_load_dwordx4 v102, s[32:35], 0 offen sc1 lds
    s_add_u32 m0, s10, 10240
    v_xor_b32_dpp v101, v4, v3 row_newbcast:10 row_mask:0xf bank_mask:0xf
    buffer_load_dwordx4 v101, s[32:35], 0 offen sc1 lds
    s_add_u32 m0, s10, 11264
    v_xor_b32_dpp v102, v4, v3 row_newbcast:11 row_mask:0xf bank_mask:0xf
    buffer_load_dwordx4 v102, s[32:35], 0 offen sc1 lds
    v_and_b32 v12, s54, v12
    v_lshlrev_b32 v60, 1, v12
    v_and_b32 v13, s54, v13
    v_lshlrev_b32 v61, 1, v13
    v_and_b32 v14, s54, v14
    v_lshlrev_b32 v62, 1, v14
    v_and_b32 v15, s54, v15
    v_lshlrev_b32 v63, 1, v15
    v_and_b32 v16, s54, v16
    v_lshlrev_b32 v64, 1, v16
    v_and_b32 v17, s54, v17
    v_lshlrev_b32 v65, 1, v17
    v_and_b32 v18, s54, v18
    v_lshlrev_b32 v66, 1, v18
    v_and_b32 v19, s54, v19
    v_lshlrev_b32 v67, 1, v19
    v_and_b32 v20, s54, v20
    v_lshlrev_b32 v68, 1, v20
    v_and_b32 v21, s54, v21
    v_lshlrev_b32 v69, 1, v21
    v_and_b32 v22, s54, v22
    v_lshlrev_b32 v70, 1, v22
    v_and_b32 v23, s54, v23
    v_lshlrev_b32 v71, 1, v23
    v_and_b32 v24, s54, v24
    v_lshlrev_b32 v72, 1, v24
    v_and_b32 v25, s54, v25
    v_lshlrev_b32 v73, 1, v25
    v_and_b32 v26, s54, v26
    v_lshlrev_b32 v74, 1, v26
    v_and_b32 v27, s54, v27
    v_lshlrev_b32 v75, 1, v27
    s_waitcnt lgkmcnt(14)
    s_mov_b64 exec, 1
L_sw_12:
    ds_read_b32 v94, v1 offset:43060
    s_waitcnt lgkmcnt(0)
    v_readfirstlane_b32 s52, v94
    s_cmp_ge_u32 s52, 4
    s_cbranch_scc1 L_sw_12_d
    s_sleep 1
    s_branch L_sw_12
L_sw_12_d:
    s_mov_b64 exec, -1
    s_mov_b64 exec, 1
    ds_add_u32 v1, v0 offset:43040
    s_mov_b64 exec, -1
    ds_read_u16_d16_hi v60, v60 offset:61438
    ds_read_u16_d16_hi v61, v61 offset:61438
    ds_read_u16_d16_hi v62, v62 offset:61438
    ds_read_u16_d16_hi v63, v63 offset:61438
    ds_read_u16_d16_hi v64, v64 offset:61438
    ds_read_u16_d16_hi v65, v65 offset:61438
    ds_read_u16_d16_hi v66, v66 offset:61438
    ds_read_u16_d16_hi v67, v67 offset:61438
    ds_read_u16_d16_hi v68, v68 offset:61438
    ds_read_u16_d16_hi v69, v69 offset:61438
    ds_read_u16_d16_hi v70, v70 offset:61438
    ds_read_u16_d16_hi v71, v71 offset:61438
    s_mov_b64 exec, 1
L_sw_13:
    ds_read_b32 v94, v1 offset:43040
    s_waitcnt lgkmcnt(0)
    v_readfirstlane_b32 s52, v94
    s_cmp_ge_u32 s52, 4
    s_cbranch_scc1 L_sw_13_d
    s_nop 0
    s_branch L_sw_13
L_sw_13_d:
    s_mov_b64 exec, -1
    ds_read_b32 v94, v92 offset:41988
    ds_read_b32 v95, v1 offset:43076
    ds_read_u16_d16_hi v72, v72 offset:61438
    ds_read_u16_d16_hi v73, v73 offset:61438
    ds_read_u16_d16_hi v74, v74 offset:61438
    ds_read_u16_d16_hi v75, v75 offset:61438
    s_cmp_lg_u32 s2, 0
    s_cbranch_scc1 L_ph2
    s_cmp_lg_u32 s3, 4
    s_cbranch_scc1 L_ph2
    s_and_b32 s52, s0, 0xfff00000
    v_mov_b32 v99, s52
    s_mov_b64 exec, 1
    global_store_dword v1, v99, s[28:29] offset:0 sc1
    s_mov_b64 exec, -1
L_ph2:
    s_mov_b32 s52, -1
    s_movk_i32 s53, 0xff
    s_mul_i32 s81, s51, 10
    s_add_u32 s54, s81, 10
    v_mov_b32 v100, 0x8000
    s_waitcnt lgkmcnt(4)
    v_add_u32 v96, 1, v94
    v_lshrrev_b32 v96, 1, v96
    v_max_u32 v96, 1, v96
    v_readfirstlane_b32 s76, v95
    v_cndmask_b32 v96, 0, v96, s[52:53]
    v_lshlrev_b32 v96, 3, v96
    v_mov_b32 v97, v96
    v_or_b32 v12, v12, v60
    v_or_b32 v13, v13, v61
    v_add_u32_dpp v97, v97, v97 row_shr:1 row_mask:0xf bank_mask:0xf
    v_or_b32 v14, v14, v62
    v_or_b32 v15, v15, v63
    v_add_u32_dpp v97, v97, v97 row_shr:2 row_mask:0xf bank_mask:0xf
    v_or_b32 v16, v16, v64
    v_or_b32 v17, v17, v65
    v_add_u32_dpp v97, v97, v97 row_shr:4 row_mask:0xf bank_mask:0xf
    v_or_b32 v18, v18, v66
    v_or_b32 v19, v19, v67
    v_add_u32_dpp v97, v97, v97 row_shr:8 row_mask:0xf bank_mask:0xf
    v_or_b32 v20, v20, v68
    v_or_b32 v21, v21, v69
    v_add_u32_dpp v97, v97, v97 row_bcast:15 row_mask:0xa bank_mask:0xf
    v_or_b32 v22, v22, v70
    v_or_b32 v23, v23, v71
    v_add_u32_dpp v97, v97, v97 row_bcast:31 row_mask:0xc bank_mask:0xf
    v_sub_u32 v98, v97, v96
    s_waitcnt lgkmcnt(0)
    v_readlane_b32 s57, v97, 63
    s_mov_b64 exec, s[52:53]
    ds_write_b32 v92, v98 offset:42500
    s_mov_b64 exec, -1
    v_readlane_b32 s77, v98, s81
    v_readlane_b32 s54, v98, s54
    v_or_b32 v24, v24, v72
    v_or_b32 v25, v25, v73
    v_or_b32 v26, v26, v74
    v_or_b32 v27, v27, v75
    s_mov_b32 s85, 0
    s_cmp_gt_u32 s57, 10240
    s_cselect_b32 s76, 1, s76
    s_mov_b32 s57, 45056
    s_cmp_lg_u32 s76, 0
    s_cbranch_scc1 L_nolist
    ds_read_b32 v60, v28 offset:42496
    ds_read_b32 v61, v29 offset:42496
    ds_read_b32 v62, v30 offset:42496
    ds_read_b32 v63, v31 offset:42496
    ds_read_b32 v64, v32 offset:42496
    ds_read_b32 v65, v33 offset:42496
    ds_read_b32 v66, v34 offset:42496
    ds_read_b32 v67, v35 offset:42496
    ds_read_b32 v68, v36 offset:42496
    ds_read_b32 v69, v37 offset:42496
    ds_read_b32 v70, v38 offset:42496
    ds_read_b32 v71, v39 offset:42496
    ds_read_b32 v72, v40 offset:42496
    s_mov_b64 exec, s[52:53]
    ds_or_b32 v97, v100 offset:45048
    s_mov_b64 exec, -1
    s_sub_u32 s85, s54, s77
    s_lshr_b32 s85, s85, 3
    s_add_u32 s78, s85, 11
    s_mul_i32 s78, s78, 5462
    s_lshr_b32 s78, s78, 16
    s_mul_i32 s57, s78, 12
    s_sub_u32 s77, s57, s85
    s_lshl_b32 s57, s57, 3
    s_sub_u32 s57, s54, s57
    s_add_u32 s57, s57, 45056
    s_sub_u32 s78, s78, 1
    s_waitcnt lgkmcnt(14)
    ds_read_b32 v73, v41 offset:42496
    s_waitcnt lgkmcnt(14)
    ds_read_b32 v74, v42 offset:42496
    s_waitcnt lgkmcnt(14)
    ds_read_b32 v75, v43 offset:42496
    s_waitcnt lgkmcnt(14)
    v_lshl_add_u32 v60, v44, 2, v60
    s_mov_b64 exec, s[60:61]
    ds_or_b32 v60, v12 offset:45056
    s_mov_b64 exec, -1
    s_waitcnt lgkmcnt(14)
    v_lshl_add_u32 v61, v45, 2, v61
    s_mov_b64 exec, s[62:63]
    ds_or_b32 v61, v13 offset:45056
    s_mov_b64 exec, -1
    s_waitcnt lgkmcnt(14)
    v_lshl_add_u32 v62, v46, 2, v62
    s_mov_b64 exec, s[64:65]
    ds_or_b32 v62, v14 offset:45056
    s_mov_b64 exec, -1
    s_waitcnt lgkmcnt(14)
    v_lshl_add_u32 v63, v47, 2, v63
    s_mov_b64 exec, s[66:67]
    ds_or_b32 v63, v15 offset:45056
    s_mov_b64 exec, -1
    s_waitcnt lgkmcnt(14)
    v_lshl_add_u32 v64, v48, 2, v64
    s_mov_b64 exec, s[68:69]
    ds_or_b32 v64, v16 offset:45056
    s_mov_b64 exec, -1
    s_waitcnt lgkmcnt(14)
    v_lshl_add_u32 v65, v49, 2, v65
    s_mov_b64 exec, s[70:71]
    ds_or_b32 v65, v17 offset:45056
    s_mov_b64 exec, -1
    s_waitcnt lgkmcnt(14)
    v_lshl_add_u32 v66, v50, 2, v66
    s_mov_b64 exec, s[72:73]
    ds_or_b32 v66, v18 offset:45056
    s_mov_b64 exec, -1
    s_waitcnt lgkmcnt(14)
    v_lshl_add_u32 v67, v51, 2, v67
    s_mov_b64 exec, s[74:75]
    ds_or_b32 v67, v19 offset:45056
    s_mov_b64 exec, -1
    s_waitcnt lgkmcnt(14)
    v_lshl_add_u32 v68, v52, 2, v68
    s_mov_b64 exec, s[16:17]
    ds_or_b32 v68, v20 offset:45056
    s_mov_b64 exec, -1
    s_waitcnt lgkmcnt(14)
    v_lshl_add_u32 v69, v53, 2, v69
    s_mov_b64 exec, s[18:19]
    ds_or_b32 v69, v21 offset:45056
    s_mov_b64 exec, -1
    s_waitcnt lgkmcnt(14)
    v_lshl_add_u32 v70, v54, 2, v70
    s_mov_b64 exec, s[20:21]
    ds_or_b32 v70, v22 offset:45056
    s_mov_b64 exec, -1
    s_waitcnt lgkmcnt(14)
    v_lshl_add_u32 v71, v55, 2, v71
    s_mov_b64 exec, s[22:23]
    ds_or_b32 v71, v23 offset:45056
    s_mov_b64 exec, -1
    s_waitcnt lgkmcnt(14)
    v_lshl_add_u32 v72, v56, 2, v72
    s_mov_b64 exec, s[24:25]
    ds_or_b32 v72, v24 offset:45056
    s_mov_b64 exec, -1
    s_waitcnt lgkmcnt(14)
    v_lshl_add_u32 v73, v57, 2, v73
    s_mov_b64 exec, s[26:27]
    ds_or_b32 v73, v25 offset:45056
    s_mov_b64 exec, -1
    s_waitcnt lgkmcnt(14)
    v_lshl_add_u32 v74, v58, 2, v74
    s_mov_b64 exec, s[40:41]
    ds_or_b32 v74, v26 offset:45056
    s_mov_b64 exec, -1
    s_waitcnt lgkmcnt(14)
    v_lshl_add_u32 v75, v59, 2, v75
    s_mov_b64 exec, s[42:43]
    ds_or_b32 v75, v27 offset:45056
    s_mov_b64 exec, -1
L_nolist:
    s_waitcnt lgkmcnt(0)
    s_mov_b64 exec, 1
    ds_add_u32 v1, v0 offset:43044
    s_mov_b64 exec, -1
    v_and_b32 v99, 15, v1
    v_lshrrev_b32 v100, 5, v1
    v_lshlrev_b32 v99, 3, v99
    v_lshl_add_u32 v99, v100, 2, v99
    v_add_u32 v7, s57, v99
    v_lshrrev_b32 v99, 1, v92
    s_mul_i32 s53, s2, 80
    v_add_u32 v94, s53, v99
    ds_read_u16_d16_hi v13, v94 offset:61440
    v_lshlrev_b32 v100, 7, v92
    v_lshlrev_b32 v99, 2, v92
    v_and_b32 v99, 0xf0, v99
    s_movk_i32 s53, 20480
    v_add3_u32 v12, v100, v99, s53
    v_mov_b32 v14, v92
    v_subrev_u32 v15, 512, v3
    v_and_b32 v32, 1, v1
    v_lshlrev_b32 v32, 4, v32
    v_mov_b32 v33, 0xffff
    v_lshlrev_b32 v33, v32, v33
    s_mov_b32 s60, 0x3000003
    s_mov_b32 s61, 0x3000003
    v_cndmask_b32 v16, 0, v33, s[60:61]
    s_mov_b32 s62, 0xc00000c
    s_mov_b32 s63, 0xc00000c
    v_cndmask_b32 v17, 0, v33, s[62:63]
    s_mov_b32 s64, 0x30000030
    s_mov_b32 s65, 0x30000030
    v_cndmask_b32 v18, 0, v33, s[64:65]
    s_mov_b32 s66, 0xc00000c0
    s_mov_b32 s67, 0xc00000c0
    v_cndmask_b32 v19, 0, v33, s[66:67]
    v_and_b32 v32, 15, v1
    v_lshlrev_b32 v32, 4, v32
    v_lshrrev_b32 v33, 5, v1
    v_lshl_or_b32 v32, v33, 8, v32
    v_bfe_u32 v33, v1, 4, 1
    v_lshl_or_b32 v29, v33, 3, v32
    v_mov_b64 v[24:25], 0
    v_mov_b64 v[26:27], 0
    s_mov_b32 s1, 0
    s_movk_i32 s11, 0x510
    s_waitcnt lgkmcnt(0)
    v_readlane_b32 s84, v12, s81
    v_readlane_b32 s82, v13, s81
    s_mov_b64 exec, 1
L_sw_14:
    ds_read_b32 v34, v1 offset:43044
    s_waitcnt lgkmcnt(0)
    v_readfirstlane_b32 s52, v34
    s_cmp_ge_u32 s52, 4
    s_cbranch_scc1 L_sw_14_d
    s_nop 0
    s_branch L_sw_14
L_sw_14_d:
    s_mov_b64 exec, -1
    s_setprio 2
    ds_read_b32 v3, v7
    ds_read_b32 v5, v7 offset:96
    ds_read_b32 v6, v7 offset:192
    v_add_u32 v7, 288, v7
    s_cmp_eq_u32 s85, 0
    s_cbranch_scc1 L_slow
    s_waitcnt lgkmcnt(1)
    v_perm_b32 v2, v3, v3, s50
    v_cmp_gt_i16 vcc, 0, v3
    v_lshlrev_b32 v3, 17, v3
    v_lshrrev_b32 v3, 8, v3
    s_mov_b32 s79, vcc_lo
    v_perm_b32 v4, v5, v5, s50
    v_cmp_gt_i16 vcc, 0, v5
    v_lshlrev_b32 v5, 17, v5
    v_lshrrev_b32 v5, 8, v5
    s_mov_b32 s80, vcc_lo
    s_cmp_ge_u32 s77, 6
    s_cbranch_scc1 L_tp_6_12
    s_cmp_ge_u32 s77, 3
    s_cbranch_scc1 L_tp_3_6
    s_cmp_ge_u32 s77, 1
    s_cbranch_scc1 L_tp_1_3
    s_branch L_pc0
L_tp_1_3:
    s_cmp_ge_u32 s77, 2
    s_cbranch_scc1 L_tp_2_3
    s_branch L_pc1
L_tp_2_3:
    s_branch L_pc2
L_tp_3_6:
    s_cmp_ge_u32 s77, 4
    s_cbranch_scc1 L_tp_4_6
    s_branch L_pc3
L_tp_4_6:
    s_cmp_ge_u32 s77, 5
    s_cbranch_scc1 L_tp_5_6
    s_branch L_pc4
L_tp_5_6:
    s_branch L_pc5
L_tp_6_12:
    s_cmp_ge_u32 s77, 9
    s_cbranch_scc1 L_tp_9_12
    s_cmp_ge_u32 s77, 7
    s_cbranch_scc1 L_tp_7_9
    s_branch L_pc6
L_tp_7_9:
    s_cmp_ge_u32 s77, 8
    s_cbranch_scc1 L_tp_8_9
    s_branch L_pc7
L_tp_8_9:
    s_branch L_pc8
L_tp_9_12:
    s_cmp_ge_u32 s77, 10
    s_cbranch_scc1 L_tp_10_12
    s_branch L_pc9
L_tp_10_12:
    s_cmp_ge_u32 s77, 11
    s_cbranch_scc1 L_tp_11_12
    s_branch L_pc10
L_tp_11_12:
    s_branch L_pc11
L_pc0:
    v_add_u32_dpp v28, v3, v15 row_newbcast:0 row_mask:0xf bank_mask:0xf
    buffer_load_dwordx4 v[60:63], v28, s[32:35], 0 offen
L_pc1:
    v_add_u32_dpp v30, v3, v15 row_newbcast:1 row_mask:0xf bank_mask:0xf
    buffer_load_dwordx4 v[64:67], v30, s[32:35], 0 offen
L_pc2:
    v_add_u32_dpp v28, v3, v15 row_newbcast:2 row_mask:0xf bank_mask:0xf
    buffer_load_dwordx4 v[68:71], v28, s[32:35], 0 offen
L_pc3:
    v_add_u32_dpp v30, v3, v15 row_newbcast:3 row_mask:0xf bank_mask:0xf
    buffer_load_dwordx4 v[72:75], v30, s[32:35], 0 offen
L_pc4:
    v_add_u32_dpp v28, v3, v15 row_newbcast:4 row_mask:0xf bank_mask:0xf
    buffer_load_dwordx4 v[76:79], v28, s[32:35], 0 offen
L_pc5:
    v_add_u32_dpp v30, v3, v15 row_newbcast:5 row_mask:0xf bank_mask:0xf
    buffer_load_dwordx4 v[80:83], v30, s[32:35], 0 offen
L_pc6:
    v_add_u32_dpp v28, v3, v15 row_newbcast:6 row_mask:0xf bank_mask:0xf
    buffer_load_dwordx4 v[84:87], v28, s[32:35], 0 offen
L_pc7:
    v_add_u32_dpp v30, v3, v15 row_newbcast:7 row_mask:0xf bank_mask:0xf
    buffer_load_dwordx4 v[88:91], v30, s[32:35], 0 offen
L_pc8:
    v_add_u32_dpp v28, v3, v15 row_newbcast:8 row_mask:0xf bank_mask:0xf
    buffer_load_dwordx4 v[92:95], v28, s[32:35], 0 offen
L_pc9:
    v_add_u32_dpp v30, v3, v15 row_newbcast:9 row_mask:0xf bank_mask:0xf
    buffer_load_dwordx4 v[96:99], v30, s[32:35], 0 offen
L_pc10:
    v_add_u32_dpp v28, v3, v15 row_newbcast:10 row_mask:0xf bank_mask:0xf
    buffer_load_dwordx4 v[100:103], v28, s[32:35], 0 offen
L_pc11:
    v_add_u32_dpp v30, v3, v15 row_newbcast:11 row_mask:0xf bank_mask:0xf
    buffer_load_dwordx4 v[104:107], v30, s[32:35], 0 offen
    s_cmp_eq_u32 s78, 0
    s_cbranch_scc1 L_ftree
    s_cmp_eq_u32 s77, 0
    s_cbranch_scc1 L_mtree
    v_add_u32_dpp v28, v5, v15 row_newbcast:0 row_mask:0xf bank_mask:0xf
    buffer_load_dwordx4 v[60:63], v28, s[32:35], 0 offen
    s_cmp_eq_u32 s77, 1
    s_cbranch_scc1 L_mtree
    v_add_u32_dpp v28, v5, v15 row_newbcast:1 row_mask:0xf bank_mask:0xf
    buffer_load_dwordx4 v[64:67], v28, s[32:35], 0 offen
    s_cmp_eq_u32 s77, 2
    s_cbranch_scc1 L_mtree
    v_add_u32_dpp v28, v5, v15 row_newbcast:2 row_mask:0xf bank_mask:0xf
    buffer_load_dwordx4 v[68:71], v28, s[32:35], 0 offen
    s_cmp_eq_u32 s77, 3
    s_cbranch_scc1 L_mtree
    v_add_u32_dpp v28, v5, v15 row_newbcast:3 row_mask:0xf bank_mask:0xf
    buffer_load_dwordx4 v[72:75], v28, s[32:35], 0 offen
    s_cmp_eq_u32 s77, 4
    s_cbranch_scc1 L_mtree
    v_add_u32_dpp v28, v5, v15 row_newbcast:4 row_mask:0xf bank_mask:0xf
    buffer_load_dwordx4 v[76:79], v28, s[32:35], 0 offen
    s_cmp_eq_u32 s77, 5
    s_cbranch_scc1 L_mtree
    v_add_u32_dpp v28, v5, v15 row_newbcast:5 row_mask:0xf bank_mask:0xf
    buffer_load_dwordx4 v[80:83], v28, s[32:35], 0 offen
    s_cmp_eq_u32 s77, 6
    s_cbranch_scc1 L_mtree
    v_add_u32_dpp v28, v5, v15 row_newbcast:6 row_mask:0xf bank_mask:0xf
    buffer_load_dwordx4 v[84:87], v28, s[32:35], 0 offen
    s_cmp_eq_u32 s77, 7
    s_cbranch_scc1 L_mtree
    v_add_u32_dpp v28, v5, v15 row_newbcast:7 row_mask:0xf bank_mask:0xf
    buffer_load_dwordx4 v[88:91], v28, s[32:35], 0 offen
    s_cmp_eq_u32 s77, 8
    s_cbranch_scc1 L_mtree
    v_add_u32_dpp v28, v5, v15 row_newbcast:8 row_mask:0xf bank_mask:0xf
    buffer_load_dwordx4 v[92:95], v28, s[32:35], 0 offen
    s_cmp_eq_u32 s77, 9
    s_cbranch_scc1 L_mtree
    v_add_u32_dpp v28, v5, v15 row_newbcast:9 row_mask:0xf bank_mask:0xf
    buffer_load_dwordx4 v[96:99], v28, s[32:35], 0 offen
    s_cmp_eq_u32 s77, 10
    s_cbranch_scc1 L_mtree
    v_add_u32_dpp v28, v5, v15 row_newbcast:10 row_mask:0xf bank_mask:0xf
    buffer_load_dwordx4 v[100:103], v28, s[32:35], 0 offen
L_mtree:
    s_waitcnt vmcnt(12)
    s_mov_b64 exec, 1
    ds_add_u32 v1, v0 offset:43008
    s_mov_b64 exec, -1
    s_cmp_ge_u32 s77, 6
    s_cbranch_scc1 L_tm_6_12
    s_cmp_ge_u32 s77, 3
    s_cbranch_scc1 L_tm_3_6
    s_cmp_ge_u32 s77, 1
    s_cbranch_scc1 L_tm_1_3
    s_branch L_m0
L_tm_1_3:
    s_cmp_ge_u32 s77, 2
    s_cbranch_scc1 L_tm_2_3
    s_branch L_m1
L_tm_2_3:
    s_branch L_m2
L_tm_3_6:
    s_cmp_ge_u32 s77, 4
    s_cbranch_scc1 L_tm_4_6
    s_branch L_m3
L_tm_4_6:
    s_cmp_ge_u32 s77, 5
    s_cbranch_scc1 L_tm_5_6
    s_branch L_m4
L_tm_5_6:
    s_branch L_m5
L_tm_6_12:
    s_cmp_ge_u32 s77, 9
    s_cbranch_scc1 L_tm_9_12
    s_cmp_ge_u32 s77, 7
    s_cbranch_scc1 L_tm_7_9
    s_branch L_m6
L_tm_7_9:
    s_cmp_ge_u32 s77, 8
    s_cbranch_scc1 L_tm_8_9
    s_branch L_m7
L_tm_8_9:
    s_branch L_m8
L_tm_9_12:
    s_cmp_ge_u32 s77, 10
    s_cbranch_scc1 L_tm_10_12
    s_branch L_m9
L_tm_10_12:
    s_cmp_ge_u32 s77, 11
    s_cbranch_scc1 L_tm_11_12
    s_branch L_m10
L_tm_11_12:
    s_branch L_m11
L_ftree:
    s_waitcnt vmcnt(0)
    s_mov_b64 exec, 1
    ds_add_u32 v1, v0 offset:43008
    s_mov_b64 exec, -1
    s_cmp_ge_u32 s77, 6
    s_cbranch_scc1 L_tf_6_12
    s_cmp_ge_u32 s77, 3
    s_cbranch_scc1 L_tf_3_6
    s_cmp_ge_u32 s77, 1
    s_cbranch_scc1 L_tf_1_3
    s_branch L_f0
L_tf_1_3:
    s_cmp_ge_u32 s77, 2
    s_cbranch_scc1 L_tf_2_3
    s_branch L_f1
L_tf_2_3:
    s_branch L_f2
L_tf_3_6:
    s_cmp_ge_u32 s77, 4
    s_cbranch_scc1 L_tf_4_6
    s_branch L_f3
L_tf_4_6:
    s_cmp_ge_u32 s77, 5
    s_cbranch_scc1 L_tf_5_6
    s_branch L_f4
L_tf_5_6:
    s_branch L_f5
L_tf_6_12:
    s_cmp_ge_u32 s77, 9
    s_cbranch_scc1 L_tf_9_12
    s_cmp_ge_u32 s77, 7
    s_cbranch_scc1 L_tf_7_9
    s_branch L_f6
L_tf_7_9:
    s_cmp_ge_u32 s77, 8
    s_cbranch_scc1 L_tf_8_9
    s_branch L_f7
L_tf_8_9:
    s_branch L_f8
L_tf_9_12:
    s_cmp_ge_u32 s77, 10
    s_cbranch_scc1 L_tf_10_12
    s_branch L_f9
L_tf_10_12:
    s_cmp_ge_u32 s77, 11
    s_cbranch_scc1 L_tf_11_12
    s_branch L_f10
L_tf_11_12:
    s_branch L_f11
L_m0:
    s_bitcmp1_b32 s79, 0
    v_and_b32_dpp v20, v2, v16 row_newbcast:0 row_mask:0xf bank_mask:0xf
    v_and_b32_dpp v21, v2, v17 row_newbcast:0 row_mask:0xf bank_mask:0xf
    v_and_b32_dpp v22, v2, v18 row_newbcast:0 row_mask:0xf bank_mask:0xf
    v_and_b32_dpp v23, v2, v19 row_newbcast:0 row_mask:0xf bank_mask:0xf
    v_add_u32_dpp v28, v5, v15 row_newbcast:0 row_mask:0xf bank_mask:0xf
    s_waitcnt vmcnt(11)
    v_mfma_f32_16x16x32_bf16 v[24:27], v[20:23], v[60:63], v[24:27]
    buffer_load_dwordx4 v[60:63], v28, s[32:35], 0 offen
    s_cbranch_scc1 L_ms0
L_m1:
    s_bitcmp1_b32 s79, 1
    v_and_b32_dpp v20, v2, v16 row_newbcast:1 row_mask:0xf bank_mask:0xf
    v_and_b32_dpp v21, v2, v17 row_newbcast:1 row_mask:0xf bank_mask:0xf
    v_and_b32_dpp v22, v2, v18 row_newbcast:1 row_mask:0xf bank_mask:0xf
    v_and_b32_dpp v23, v2, v19 row_newbcast:1 row_mask:0xf bank_mask:0xf
    v_add_u32_dpp v28, v5, v15 row_newbcast:1 row_mask:0xf bank_mask:0xf
    s_waitcnt vmcnt(11)
    v_mfma_f32_16x16x32_bf16 v[24:27], v[20:23], v[64:67], v[24:27]
    buffer_load_dwordx4 v[64:67], v28, s[32:35], 0 offen
    s_cbranch_scc1 L_ms1
L_m2:
    s_bitcmp1_b32 s79, 2
    v_and_b32_dpp v20, v2, v16 row_newbcast:2 row_mask:0xf bank_mask:0xf
    v_and_b32_dpp v21, v2, v17 row_newbcast:2 row_mask:0xf bank_mask:0xf
    v_and_b32_dpp v22, v2, v18 row_newbcast:2 row_mask:0xf bank_mask:0xf
    v_and_b32_dpp v23, v2, v19 row_newbcast:2 row_mask:0xf bank_mask:0xf
    v_add_u32_dpp v28, v5, v15 row_newbcast:2 row_mask:0xf bank_mask:0xf
    s_waitcnt vmcnt(11)
    v_mfma_f32_16x16x32_bf16 v[24:27], v[20:23], v[68:71], v[24:27]
    buffer_load_dwordx4 v[68:71], v28, s[32:35], 0 offen
    s_cbranch_scc1 L_ms2
L_m3:
    s_bitcmp1_b32 s79, 3
    v_and_b32_dpp v20, v2, v16 row_newbcast:3 row_mask:0xf bank_mask:0xf
    v_and_b32_dpp v21, v2, v17 row_newbcast:3 row_mask:0xf bank_mask:0xf
    v_and_b32_dpp v22, v2, v18 row_newbcast:3 row_mask:0xf bank_mask:0xf
    v_and_b32_dpp v23, v2, v19 row_newbcast:3 row_mask:0xf bank_mask:0xf
    v_add_u32_dpp v28, v5, v15 row_newbcast:3 row_mask:0xf bank_mask:0xf
    s_waitcnt vmcnt(11)
    v_mfma_f32_16x16x32_bf16 v[24:27], v[20:23], v[72:75], v[24:27]
    buffer_load_dwordx4 v[72:75], v28, s[32:35], 0 offen
    s_cbranch_scc1 L_ms3
L_m4:
    s_bitcmp1_b32 s79, 4
    v_and_b32_dpp v20, v2, v16 row_newbcast:4 row_mask:0xf bank_mask:0xf
    v_and_b32_dpp v21, v2, v17 row_newbcast:4 row_mask:0xf bank_mask:0xf
    v_and_b32_dpp v22, v2, v18 row_newbcast:4 row_mask:0xf bank_mask:0xf
    v_and_b32_dpp v23, v2, v19 row_newbcast:4 row_mask:0xf bank_mask:0xf
    v_add_u32_dpp v28, v5, v15 row_newbcast:4 row_mask:0xf bank_mask:0xf
    s_waitcnt vmcnt(11)
    v_mfma_f32_16x16x32_bf16 v[24:27], v[20:23], v[76:79], v[24:27]
    buffer_load_dwordx4 v[76:79], v28, s[32:35], 0 offen
    s_cbranch_scc1 L_ms4
L_m5:
    s_bitcmp1_b32 s79, 5
    v_and_b32_dpp v20, v2, v16 row_newbcast:5 row_mask:0xf bank_mask:0xf
    v_and_b32_dpp v21, v2, v17 row_newbcast:5 row_mask:0xf bank_mask:0xf
    v_and_b32_dpp v22, v2, v18 row_newbcast:5 row_mask:0xf bank_mask:0xf
    v_and_b32_dpp v23, v2, v19 row_newbcast:5 row_mask:0xf bank_mask:0xf
    v_add_u32_dpp v28, v5, v15 row_newbcast:5 row_mask:0xf bank_mask:0xf
    s_waitcnt vmcnt(11)
    v_mfma_f32_16x16x32_bf16 v[24:27], v[20:23], v[80:83], v[24:27]
    buffer_load_dwordx4 v[80:83], v28, s[32:35], 0 offen
    s_cbranch_scc1 L_ms5
L_m6:
    s_bitcmp1_b32 s79, 6
    v_and_b32_dpp v20, v2, v16 row_newbcast:6 row_mask:0xf bank_mask:0xf
    v_and_b32_dpp v21, v2, v17 row_newbcast:6 row_mask:0xf bank_mask:0xf
    v_and_b32_dpp v22, v2, v18 row_newbcast:6 row_mask:0xf bank_mask:0xf
    v_and_b32_dpp v23, v2, v19 row_newbcast:6 row_mask:0xf bank_mask:0xf
    v_add_u32_dpp v28, v5, v15 row_newbcast:6 row_mask:0xf bank_mask:0xf
    s_waitcnt vmcnt(11)
    v_mfma_f32_16x16x32_bf16 v[24:27], v[20:23], v[84:87], v[24:27]
    buffer_load_dwordx4 v[84:87], v28, s[32:35], 0 offen
    s_cbranch_scc1 L_ms6
L_m7:
    s_bitcmp1_b32 s79, 7
    v_and_b32_dpp v20, v2, v16 row_newbcast:7 row_mask:0xf bank_mask:0xf
    v_and_b32_dpp v21, v2, v17 row_newbcast:7 row_mask:0xf bank_mask:0xf
    v_and_b32_dpp v22, v2, v18 row_newbcast:7 row_mask:0xf bank_mask:0xf
    v_and_b32_dpp v23, v2, v19 row_newbcast:7 row_mask:0xf bank_mask:0xf
    v_add_u32_dpp v28, v5, v15 row_newbcast:7 row_mask:0xf bank_mask:0xf
    s_waitcnt vmcnt(11)
    v_mfma_f32_16x16x32_bf16 v[24:27], v[20:23], v[88:91], v[24:27]
    buffer_load_dwordx4 v[88:91], v28, s[32:35], 0 offen
    s_cbranch_scc1 L_ms7
L_m8:
    s_bitcmp1_b32 s79, 8
    v_and_b32_dpp v20, v2, v16 row_newbcast:8 row_mask:0xf bank_mask:0xf
    v_and_b32_dpp v21, v2, v17 row_newbcast:8 row_mask:0xf bank_mask:0xf
    v_and_b32_dpp v22, v2, v18 row_newbcast:8 row_mask:0xf bank_mask:0xf
    v_and_b32_dpp v23, v2, v19 row_newbcast:8 row_mask:0xf bank_mask:0xf
    v_add_u32_dpp v28, v5, v15 row_newbcast:8 row_mask:0xf bank_mask:0xf
    s_waitcnt vmcnt(11)
    v_mfma_f32_16x16x32_bf16 v[24:27], v[20:23], v[92:95], v[24:27]
    buffer_load_dwordx4 v[92:95], v28, s[32:35], 0 offen
    s_cbranch_scc1 L_ms8
L_m9:
    s_bitcmp1_b32 s79, 9
    v_and_b32_dpp v20, v2, v16 row_newbcast:9 row_mask:0xf bank_mask:0xf
    v_and_b32_dpp v21, v2, v17 row_newbcast:9 row_mask:0xf bank_mask:0xf
    v_and_b32_dpp v22, v2, v18 row_newbcast:9 row_mask:0xf bank_mask:0xf
    v_and_b32_dpp v23, v2, v19 row_newbcast:9 row_mask:0xf bank_mask:0xf
    v_add_u32_dpp v28, v5, v15 row_newbcast:9 row_mask:0xf bank_mask:0xf
    s_waitcnt vmcnt(11)
    v_mfma_f32_16x16x32_bf16 v[24:27], v[20:23], v[96:99], v[24:27]
    buffer_load_dwordx4 v[96:99], v28, s[32:35], 0 offen
    s_cbranch_scc1 L_ms9
L_m10:
    s_bitcmp1_b32 s79, 10
    v_and_b32_dpp v20, v2, v16 row_newbcast:10 row_mask:0xf bank_mask:0xf
    v_and_b32_dpp v21, v2, v17 row_newbcast:10 row_mask:0xf bank_mask:0xf
    v_and_b32_dpp v22, v2, v18 row_newbcast:10 row_mask:0xf bank_mask:0xf
    v_and_b32_dpp v23, v2, v19 row_newbcast:10 row_mask:0xf bank_mask:0xf
    v_add_u32_dpp v28, v5, v15 row_newbcast:10 row_mask:0xf bank_mask:0xf
    s_waitcnt vmcnt(11)
    v_mfma_f32_16x16x32_bf16 v[24:27], v[20:23], v[100:103], v[24:27]
    buffer_load_dwordx4 v[100:103], v28, s[32:35], 0 offen
    s_cbranch_scc1 L_ms10
L_m11:
    s_bitcmp1_b32 s79, 11
    v_and_b32_dpp v20, v2, v16 row_newbcast:11 row_mask:0xf bank_mask:0xf
    v_and_b32_dpp v21, v2, v17 row_newbcast:11 row_mask:0xf bank_mask:0xf
    v_and_b32_dpp v22, v2, v18 row_newbcast:11 row_mask:0xf bank_mask:0xf
    v_and_b32_dpp v23, v2, v19 row_newbcast:11 row_mask:0xf bank_mask:0xf
    v_add_u32_dpp v28, v5, v15 row_newbcast:11 row_mask:0xf bank_mask:0xf
    s_waitcnt vmcnt(11)
    v_mfma_f32_16x16x32_bf16 v[24:27], v[20:23], v[104:107], v[24:27]
    buffer_load_dwordx4 v[104:107], v28, s[32:35], 0 offen
    s_cbranch_scc1 L_ms11
L_m12:
    v_mov_b32 v2, v4
    s_mov_b32 s79, s80
    s_sub_u32 s78, s78, 1
    s_cmp_eq_u32 s78, 0
    s_cbranch_scc1 L_f0
    s_waitcnt lgkmcnt(0)
    v_cmp_gt_i16 vcc, 0, v6
    v_lshlrev_b32 v5, 17, v6
    v_perm_b32 v4, v6, v6, s50
    v_lshrrev_b32 v5, 8, v5
    ds_read_b32 v6, v7
    s_mov_b32 s80, vcc_lo
    v_add_u32 v7, 96, v7
    s_branch L_m0
L_f0:
    v_and_b32_dpp v20, v2, v16 row_newbcast:0 row_mask:0xf bank_mask:0xf
    v_and_b32_dpp v21, v2, v17 row_newbcast:0 row_mask:0xf bank_mask:0xf
    v_and_b32_dpp v22, v2, v18 row_newbcast:0 row_mask:0xf bank_mask:0xf
    v_and_b32_dpp v23, v2, v19 row_newbcast:0 row_mask:0xf bank_mask:0xf
    s_bitcmp1_b32 s79, 0
    s_waitcnt vmcnt(11)
    v_mfma_f32_16x16x32_bf16 v[24:27], v[20:23], v[60:63], v[24:27]
    s_cbranch_scc1 L_fs0
L_f1:
    v_and_b32_dpp v20, v2, v16 row_newbcast:1 row_mask:0xf bank_mask:0xf
    v_and_b32_dpp v21, v2, v17 row_newbcast:1 row_mask:0xf bank_mask:0xf
    v_and_b32_dpp v22, v2, v18 row_newbcast:1 row_mask:0xf bank_mask:0xf
    v_and_b32_dpp v23, v2, v19 row_newbcast:1 row_mask:0xf bank_mask:0xf
    s_bitcmp1_b32 s79, 1
    s_waitcnt vmcnt(10)
    v_mfma_f32_16x16x32_bf16 v[24:27], v[20:23], v[64:67], v[24:27]
    s_cbranch_scc1 L_fs1
L_f2:
    v_and_b32_dpp v20, v2, v16 row_newbcast:2 row_mask:0xf bank_mask:0xf
    v_and_b32_dpp v21, v2, v17 row_newbcast:2 row_mask:0xf bank_mask:0xf
    v_and_b32_dpp v22, v2, v18 row_newbcast:2 row_mask:0xf bank_mask:0xf
    v_and_b32_dpp v23, v2, v19 row_newbcast:2 row_mask:0xf bank_mask:0xf
    s_bitcmp1_b32 s79, 2
    s_waitcnt vmcnt(9)
    v_mfma_f32_16x16x32_bf16 v[24:27], v[20:23], v[68:71], v[24:27]
    s_cbranch_scc1 L_fs2
L_f3:
    v_and_b32_dpp v20, v2, v16 row_newbcast:3 row_mask:0xf bank_mask:0xf
    v_and_b32_dpp v21, v2, v17 row_newbcast:3 row_mask:0xf bank_mask:0xf
    v_and_b32_dpp v22, v2, v18 row_newbcast:3 row_mask:0xf bank_mask:0xf
    v_and_b32_dpp v23, v2, v19 row_newbcast:3 row_mask:0xf bank_mask:0xf
    s_bitcmp1_b32 s79, 3
    s_waitcnt vmcnt(8)
    v_mfma_f32_16x16x32_bf16 v[24:27], v[20:23], v[72:75], v[24:27]
    s_cbranch_scc1 L_fs3
L_f4:
    v_and_b32_dpp v20, v2, v16 row_newbcast:4 row_mask:0xf bank_mask:0xf
    v_and_b32_dpp v21, v2, v17 row_newbcast:4 row_mask:0xf bank_mask:0xf
    v_and_b32_dpp v22, v2, v18 row_newbcast:4 row_mask:0xf bank_mask:0xf
    v_and_b32_dpp v23, v2, v19 row_newbcast:4 row_mask:0xf bank_mask:0xf
    s_bitcmp1_b32 s79, 4
    s_waitcnt vmcnt(7)
    v_mfma_f32_16x16x32_bf16 v[24:27], v[20:23], v[76:79], v[24:27]
    s_cbranch_scc1 L_fs4
L_f5:
    v_and_b32_dpp v20, v2, v16 row_newbcast:5 row_mask:0xf bank_mask:0xf
    v_and_b32_dpp v21, v2, v17 row_newbcast:5 row_mask:0xf bank_mask:0xf
    v_and_b32_dpp v22, v2, v18 row_newbcast:5 row_mask:0xf bank_mask:0xf
    v_and_b32_dpp v23, v2, v19 row_newbcast:5 row_mask:0xf bank_mask:0xf
    s_bitcmp1_b32 s79, 5
    s_waitcnt vmcnt(6)
    v_mfma_f32_16x16x32_bf16 v[24:27], v[20:23], v[80:83], v[24:27]
    s_cbranch_scc1 L_fs5
L_f6:
    v_and_b32_dpp v20, v2, v16 row_newbcast:6 row_mask:0xf bank_mask:0xf
    v_and_b32_dpp v21, v2, v17 row_newbcast:6 row_mask:0xf bank_mask:0xf
    v_and_b32_dpp v22, v2, v18 row_newbcast:6 row_mask:0xf bank_mask:0xf
    v_and_b32_dpp v23, v2, v19 row_newbcast:6 row_mask:0xf bank_mask:0xf
    s_bitcmp1_b32 s79, 6
    s_waitcnt vmcnt(5)
    v_mfma_f32_16x16x32_bf16 v[24:27], v[20:23], v[84:87], v[24:27]
    s_cbranch_scc1 L_fs6
L_f7:
    v_and_b32_dpp v20, v2, v16 row_newbcast:7 row_mask:0xf bank_mask:0xf
    v_and_b32_dpp v21, v2, v17 row_newbcast:7 row_mask:0xf bank_mask:0xf
    v_and_b32_dpp v22, v2, v18 row_newbcast:7 row_mask:0xf bank_mask:0xf
    v_and_b32_dpp v23, v2, v19 row_newbcast:7 row_mask:0xf bank_mask:0xf
    s_bitcmp1_b32 s79, 7
    s_waitcnt vmcnt(4)
    v_mfma_f32_16x16x32_bf16 v[24:27], v[20:23], v[88:91], v[24:27]
    s_cbranch_scc1 L_fs7
L_f8:
    v_and_b32_dpp v20, v2, v16 row_newbcast:8 row_mask:0xf bank_mask:0xf
    v_and_b32_dpp v21, v2, v17 row_newbcast:8 row_mask:0xf bank_mask:0xf
    v_and_b32_dpp v22, v2, v18 row_newbcast:8 row_mask:0xf bank_mask:0xf
    v_and_b32_dpp v23, v2, v19 row_newbcast:8 row_mask:0xf bank_mask:0xf
    s_bitcmp1_b32 s79, 8
    s_waitcnt vmcnt(3)
    v_mfma_f32_16x16x32_bf16 v[24:27], v[20:23], v[92:95], v[24:27]
    s_cbranch_scc1 L_fs8
L_f9:
    v_and_b32_dpp v20, v2, v16 row_newbcast:9 row_mask:0xf bank_mask:0xf
    v_and_b32_dpp v21, v2, v17 row_newbcast:9 row_mask:0xf bank_mask:0xf
    v_and_b32_dpp v22, v2, v18 row_newbcast:9 row_mask:0xf bank_mask:0xf
    v_and_b32_dpp v23, v2, v19 row_newbcast:9 row_mask:0xf bank_mask:0xf
    s_bitcmp1_b32 s79, 9
    s_waitcnt vmcnt(2)
    v_mfma_f32_16x16x32_bf16 v[24:27], v[20:23], v[96:99], v[24:27]
    s_cbranch_scc1 L_fs9
L_f10:
    v_and_b32_dpp v20, v2, v16 row_newbcast:10 row_mask:0xf bank_mask:0xf
    v_and_b32_dpp v21, v2, v17 row_newbcast:10 row_mask:0xf bank_mask:0xf
    v_and_b32_dpp v22, v2, v18 row_newbcast:10 row_mask:0xf bank_mask:0xf
    v_and_b32_dpp v23, v2, v19 row_newbcast:10 row_mask:0xf bank_mask:0xf
    s_bitcmp1_b32 s79, 10
    s_waitcnt vmcnt(1)
    v_mfma_f32_16x16x32_bf16 v[24:27], v[20:23], v[100:103], v[24:27]
    s_cbranch_scc1 L_fs10
L_f11:
    v_and_b32_dpp v20, v2, v16 row_newbcast:11 row_mask:0xf bank_mask:0xf
    v_and_b32_dpp v21, v2, v17 row_newbcast:11 row_mask:0xf bank_mask:0xf
    v_and_b32_dpp v22, v2, v18 row_newbcast:11 row_mask:0xf bank_mask:0xf
    v_and_b32_dpp v23, v2, v19 row_newbcast:11 row_mask:0xf bank_mask:0xf
    s_bitcmp1_b32 s79, 11
    s_waitcnt vmcnt(0)
    v_mfma_f32_16x16x32_bf16 v[24:27], v[20:23], v[104:107], v[24:27]
    s_nop 2
    s_call_b64 s[30:31], L_flush
    s_branch L_Bdone
L_ms0:
    s_nop 0
    v_xor_b32 v30, s84, v29
    s_add_u32 s1, s1, 1
    s_add_u32 s81, s81, 1
    s_bitcmp1_b32 s11, s1
    s_nop 1
    v_pk_mul_f32 v[34:35], v[24:25], s[82:83] op_sel_hi:[1,0]
    v_pk_mul_f32 v[36:37], v[26:27], s[82:83] op_sel_hi:[1,0]
    v_readlane_b32 s84, v12, s81
    v_cvt_pk_bf16_f32 v32, v34, v35
    v_cvt_pk_bf16_f32 v33, v36, v37
    v_readlane_b32 s82, v13, s81
    ds_write_b64 v30, v[32:33]
    v_mov_b64 v[24:25], 0
    v_mov_b64 v[26:27], 0
    s_cbranch_scc0 L_m1
    s_call_b64 s[30:31], L_fl_x
    s_branch L_m1
L_ms1:
    s_nop 0
    v_xor_b32 v30, s84, v29
    s_add_u32 s1, s1, 1
    s_add_u32 s81, s81, 1
    s_bitcmp1_b32 s11, s1
    s_nop 1
    v_pk_mul_f32 v[34:35], v[24:25], s[82:83] op_sel_hi:[1,0]
    v_pk_mul_f32 v[36:37], v[26:27], s[82:83] op_sel_hi:[1,0]
    v_readlane_b32 s84, v12, s81
    v_cvt_pk_bf16_f32 v32, v34, v35
    v_cvt_pk_bf16_f32 v33, v36, v37
    v_readlane_b32 s82, v13, s81
    ds_write_b64 v30, v[32:33]
    v_mov_b64 v[24:25], 0
    v_mov_b64 v[26:27], 0
    s_cbranch_scc0 L_m2
    s_call_b64 s[30:31], L_fl_x
    s_branch L_m2
L_ms2:
    s_nop 0
    v_xor_b32 v30, s84, v29
    s_add_u32 s1, s1, 1
    s_add_u32 s81, s81, 1
    s_bitcmp1_b32 s11, s1
    s_nop 1
    v_pk_mul_f32 v[34:35], v[24:25], s[82:83] op_sel_hi:[1,0]
    v_pk_mul_f32 v[36:37], v[26:27], s[82:83] op_sel_hi:[1,0]
    v_readlane_b32 s84, v12, s81
    v_cvt_pk_bf16_f32 v32, v34, v35
    v_cvt_pk_bf16_f32 v33, v36, v37
    v_readlane_b32 s82, v13, s81
    ds_write_b64 v30, v[32:33]
    v_mov_b64 v[24:25], 0
    v_mov_b64 v[26:27], 0
    s_cbranch_scc0 L_m3
    s_call_b64 s[30:31], L_fl_x
    s_branch L_m3
L_ms3:
    s_nop 0
    v_xor_b32 v30, s84, v29
    s_add_u32 s1, s1, 1
    s_add_u32 s81, s81, 1
    s_bitcmp1_b32 s11, s1
    s_nop 1
    v_pk_mul_f32 v[34:35], v[24:25], s[82:83] op_sel_hi:[1,0]
    v_pk_mul_f32 v[36:37], v[26:27], s[82:83] op_sel_hi:[1,0]
    v_readlane_b32 s84, v12, s81
    v_cvt_pk_bf16_f32 v32, v34, v35
    v_cvt_pk_bf16_f32 v33, v36, v37
    v_readlane_b32 s82, v13, s81
    ds_write_b64 v30, v[32:33]
    v_mov_b64 v[24:25], 0
    v_mov_b64 v[26:27], 0
    s_cbranch_scc0 L_m4
    s_call_b64 s[30:31], L_fl_x
    s_branch L_m4
L_ms4:
    s_nop 0
    v_xor_b32 v30, s84, v29
    s_add_u32 s1, s1, 1
    s_add_u32 s81, s81, 1
    s_bitcmp1_b32 s11, s1
    s_nop 1
    v_pk_mul_f32 v[34:35], v[24:25], s[82:83] op_sel_hi:[1,0]
    v_pk_mul_f32 v[36:37], v[26:27], s[82:83] op_sel_hi:[1,0]
    v_readlane_b32 s84, v12, s81
    v_cvt_pk_bf16_f32 v32, v34, v35
    v_cvt_pk_bf16_f32 v33, v36, v37
    v_readlane_b32 s82, v13, s81
    ds_write_b64 v30, v[32:33]
    v_mov_b64 v[24:25], 0
    v_mov_b64 v[26:27], 0
    s_cbranch_scc0 L_m5
    s_call_b64 s[30:31], L_fl_x
    s_branch L_m5
L_ms5:
    s_nop 0
    v_xor_b32 v30, s84, v29
    s_add_u32 s1, s1, 1
    s_add_u32 s81, s81, 1
    s_bitcmp1_b32 s11, s1
    s_nop 1
    v_pk_mul_f32 v[34:35], v[24:25], s[82:83] op_sel_hi:[1,0]
    v_pk_mul_f32 v[36:37], v[26:27], s[82:83] op_sel_hi:[1,0]
    v_readlane_b32 s84, v12, s81
    v_cvt_pk_bf16_f32 v32, v34, v35
    v_cvt_pk_bf16_f32 v33, v36, v37
    v_readlane_b32 s82, v13, s81
    ds_write_b64 v30, v[32:33]
    v_mov_b64 v[24:25], 0
    v_mov_b64 v[26:27], 0
    s_cbranch_scc0 L_m6
    s_call_b64 s[30:31], L_fl_x
    s_branch L_m6
L_ms6:
    s_nop 0
    v_xor_b32 v30, s84, v29
    s_add_u32 s1, s1, 1
    s_add_u32 s81, s81, 1
    s_bitcmp1_b32 s11, s1
    s_nop 1
    v_pk_mul_f32 v[34:35], v[24:25], s[82:83] op_sel_hi:[1,0]
    v_pk_mul_f32 v[36:37], v[26:27], s[82:83] op_sel_hi:[1,0]
    v_readlane_b32 s84, v12, s81
    v_cvt_pk_bf16_f32 v32, v34, v35
    v_cvt_pk_bf16_f32 v33, v36, v37
    v_readlane_b32 s82, v13, s81
    ds_write_b64 v30, v[32:33]
    v_mov_b64 v[24:25], 0
    v_mov_b64 v[26:27], 0
    s_cbranch_scc0 L_m7
    s_call_b64 s[30:31], L_fl_x
    s_branch L_m7
L_ms7:
    s_nop 0
    v_xor_b32 v30, s84, v29
    s_add_u32 s1, s1, 1
    s_add_u32 s81, s81, 1
    s_bitcmp1_b32 s11, s1
    s_nop 1
    v_pk_mul_f32 v[34:35], v[24:25], s[82:83] op_sel_hi:[1,0]
    v_pk_mul_f32 v[36:37], v[26:27], s[82:83] op_sel_hi:[1,0]
    v_readlane_b32 s84, v12, s81
    v_cvt_pk_bf16_f32 v32, v34, v35
    v_cvt_pk_bf16_f32 v33, v36, v37
    v_readlane_b32 s82, v13, s81
    ds_write_b64 v30, v[32:33]
    v_mov_b64 v[24:25], 0
    v_mov_b64 v[26:27], 0
    s_cbranch_scc0 L_m8
    s_call_b64 s[30:31], L_fl_x
    s_branch L_m8
L_ms8:
    s_nop 0
    v_xor_b32 v30, s84, v29
    s_add_u32 s1, s1, 1
    s_add_u32 s81, s81, 1
    s_bitcmp1_b32 s11, s1
    s_nop 1
    v_pk_mul_f32 v[34:35], v[24:25], s[82:83] op_sel_hi:[1,0]
    v_pk_mul_f32 v[36:37], v[26:27], s[82:83] op_sel_hi:[1,0]
    v_readlane_b32 s84, v12, s81
    v_cvt_pk_bf16_f32 v32, v34, v35
    v_cvt_pk_bf16_f32 v33, v36, v37
    v_readlane_b32 s82, v13, s81
    ds_write_b64 v30, v[32:33]
    v_mov_b64 v[24:25], 0
    v_mov_b64 v[26:27], 0
    s_cbranch_scc0 L_m9
    s_call_b64 s[30:31], L_fl_x
    s_branch L_m9
L_ms9:
    s_nop 0
    v_xor_b32 v30, s84, v29
    s_add_u32 s1, s1, 1
    s_add_u32 s81, s81, 1
    s_bitcmp1_b32 s11, s1
    s_nop 1
    v_pk_mul_f32 v[34:35], v[24:25], s[82:83] op_sel_hi:[1,0]
    v_pk_mul_f32 v[36:37], v[26:27], s[82:83] op_sel_hi:[1,0]
    v_readlane_b32 s84, v12, s81
    v_cvt_pk_bf16_f32 v32, v34, v35
    v_cvt_pk_bf16_f32 v33, v36, v37
    v_readlane_b32 s82, v13, s81
    ds_write_b64 v30, v[32:33]
    v_mov_b64 v[24:25], 0
    v_mov_b64 v[26:27], 0
    s_cbranch_scc0 L_m10
    s_call_b64 s[30:31], L_fl_x
    s_branch L_m10
L_ms10:
    s_nop 0
    v_xor_b32 v30, s84, v29
    s_add_u32 s1, s1, 1
    s_add_u32 s81, s81, 1
    s_bitcmp1_b32 s11, s1
    s_nop 1
    v_pk_mul_f32 v[34:35], v[24:25], s[82:83] op_sel_hi:[1,0]
    v_pk_mul_f32 v[36:37], v[26:27], s[82:83] op_sel_hi:[1,0]
    v_readlane_b32 s84, v12, s81
    v_cvt_pk_bf16_f32 v32, v34, v35
    v_cvt_pk_bf16_f32 v33, v36, v37
    v_readlane_b32 s82, v13, s81
    ds_write_b64 v30, v[32:33]
    v_mov_b64 v[24:25], 0
    v_mov_b64 v[26:27], 0
    s_cbranch_scc0 L_m11
    s_call_b64 s[30:31], L_fl_x
    s_branch L_m11
L_ms11:
    s_nop 0
    v_xor_b32 v30, s84, v29
    s_add_u32 s1, s1, 1
    s_add_u32 s81, s81, 1
    s_bitcmp1_b32 s11, s1
    s_nop 1
    v_pk_mul_f32 v[34:35], v[24:25], s[82:83] op_sel_hi:[1,0]
    v_pk_mul_f32 v[36:37], v[26:27], s[82:83] op_sel_hi:[1,0]
    v_readlane_b32 s84, v12, s81
    v_cvt_pk_bf16_f32 v32, v34, v35
    v_cvt_pk_bf16_f32 v33, v36, v37
    v_readlane_b32 s82, v13, s81
    ds_write_b64 v30, v[32:33]
    v_mov_b64 v[24:25], 0
    v_mov_b64 v[26:27], 0
    s_cbranch_scc0 L_m12
    s_call_b64 s[30:31], L_fl_x
    s_branch L_m12
L_fs0:
    s_nop 1
    v_xor_b32 v30, s84, v29
    s_add_u32 s1, s1, 1
    s_add_u32 s81, s81, 1
    s_bitcmp1_b32 s11, s1
    s_nop 1
    v_pk_mul_f32 v[34:35], v[24:25], s[82:83] op_sel_hi:[1,0]
    v_pk_mul_f32 v[36:37], v[26:27], s[82:83] op_sel_hi:[1,0]
    v_readlane_b32 s84, v12, s81
    v_cvt_pk_bf16_f32 v32, v34, v35
    v_cvt_pk_bf16_f32 v33, v36, v37
    v_readlane_b32 s82, v13, s81
    ds_write_b64 v30, v[32:33]
    v_mov_b64 v[24:25], 0
    v_mov_b64 v[26:27], 0
    s_cbranch_scc0 L_f1
    s_call_b64 s[30:31], L_fl_x
    s_branch L_f1
L_fs1:
    s_nop 1
    v_xor_b32 v30, s84, v29
    s_add_u32 s1, s1, 1
    s_add_u32 s81, s81, 1
    s_bitcmp1_b32 s11, s1
    s_nop 1
    v_pk_mul_f32 v[34:35], v[24:25], s[82:83] op_sel_hi:[1,0]
    v_pk_mul_f32 v[36:37], v[26:27], s[82:83] op_sel_hi:[1,0]
    v_readlane_b32 s84, v12, s81
    v_cvt_pk_bf16_f32 v32, v34, v35
    v_cvt_pk_bf16_f32 v33, v36, v37
    v_readlane_b32 s82, v13, s81
    ds_write_b64 v30, v[32:33]
    v_mov_b64 v[24:25], 0
    v_mov_b64 v[26:27], 0
    s_cbranch_scc0 L_f2
    s_call_b64 s[30:31], L_fl_x
    s_branch L_f2
L_fs2:
    s_nop 1
    v_xor_b32 v30, s84, v29
    s_add_u32 s1, s1, 1
    s_add_u32 s81, s81, 1
    s_bitcmp1_b32 s11, s1
    s_nop 1
    v_pk_mul_f32 v[34:35], v[24:25], s[82:83] op_sel_hi:[1,0]
    v_pk_mul_f32 v[36:37], v[26:27], s[82:83] op_sel_hi:[1,0]
    v_readlane_b32 s84, v12, s81
    v_cvt_pk_bf16_f32 v32, v34, v35
    v_cvt_pk_bf16_f32 v33, v36, v37
    v_readlane_b32 s82, v13, s81
    ds_write_b64 v30, v[32:33]
    v_mov_b64 v[24:25], 0
    v_mov_b64 v[26:27], 0
    s_cbranch_scc0 L_f3
    s_call_b64 s[30:31], L_fl_x
    s_branch L_f3
L_fs3:
    s_nop 1
    v_xor_b32 v30, s84, v29
    s_add_u32 s1, s1, 1
    s_add_u32 s81, s81, 1
    s_bitcmp1_b32 s11, s1
    s_nop 1
    v_pk_mul_f32 v[34:35], v[24:25], s[82:83] op_sel_hi:[1,0]
    v_pk_mul_f32 v[36:37], v[26:27], s[82:83] op_sel_hi:[1,0]
    v_readlane_b32 s84, v12, s81
    v_cvt_pk_bf16_f32 v32, v34, v35
    v_cvt_pk_bf16_f32 v33, v36, v37
    v_readlane_b32 s82, v13, s81
    ds_write_b64 v30, v[32:33]
    v_mov_b64 v[24:25], 0
    v_mov_b64 v[26:27], 0
    s_cbranch_scc0 L_f4
    s_call_b64 s[30:31], L_fl_x
    s_branch L_f4
L_fs4:
    s_nop 1
    v_xor_b32 v30, s84, v29
    s_add_u32 s1, s1, 1
    s_add_u32 s81, s81, 1
    s_bitcmp1_b32 s11, s1
    s_nop 1
    v_pk_mul_f32 v[34:35], v[24:25], s[82:83] op_sel_hi:[1,0]
    v_pk_mul_f32 v[36:37], v[26:27], s[82:83] op_sel_hi:[1,0]
    v_readlane_b32 s84, v12, s81
    v_cvt_pk_bf16_f32 v32, v34, v35
    v_cvt_pk_bf16_f32 v33, v36, v37
    v_readlane_b32 s82, v13, s81
    ds_write_b64 v30, v[32:33]
    v_mov_b64 v[24:25], 0
    v_mov_b64 v[26:27], 0
    s_cbranch_scc0 L_f5
    s_call_b64 s[30:31], L_fl_x
    s_branch L_f5
L_fs5:
    s_nop 1
    v_xor_b32 v30, s84, v29
    s_add_u32 s1, s1, 1
    s_add_u32 s81, s81, 1
    s_bitcmp1_b32 s11, s1
    s_nop 1
    v_pk_mul_f32 v[34:35], v[24:25], s[82:83] op_sel_hi:[1,0]
    v_pk_mul_f32 v[36:37], v[26:27], s[82:83] op_sel_hi:[1,0]
    v_readlane_b32 s84, v12, s81
    v_cvt_pk_bf16_f32 v32, v34, v35
    v_cvt_pk_bf16_f32 v33, v36, v37
    v_readlane_b32 s82, v13, s81
    ds_write_b64 v30, v[32:33]
    v_mov_b64 v[24:25], 0
    v_mov_b64 v[26:27], 0
    s_cbranch_scc0 L_f6
    s_call_b64 s[30:31], L_fl_x
    s_branch L_f6
L_fs6:
    s_nop 1
    v_xor_b32 v30, s84, v29
    s_add_u32 s1, s1, 1
    s_add_u32 s81, s81, 1
    s_bitcmp1_b32 s11, s1
    s_nop 1
    v_pk_mul_f32 v[34:35], v[24:25], s[82:83] op_sel_hi:[1,0]
    v_pk_mul_f32 v[36:37], v[26:27], s[82:83] op_sel_hi:[1,0]
    v_readlane_b32 s84, v12, s81
    v_cvt_pk_bf16_f32 v32, v34, v35
    v_cvt_pk_bf16_f32 v33, v36, v37
    v_readlane_b32 s82, v13, s81
    ds_write_b64 v30, v[32:33]
    v_mov_b64 v[24:25], 0
    v_mov_b64 v[26:27], 0
    s_cbranch_scc0 L_f7
    s_call_b64 s[30:31], L_fl_x
    s_branch L_f7
L_fs7:
    s_nop 1
    v_xor_b32 v30, s84, v29
    s_add_u32 s1, s1, 1
    s_add_u32 s81, s81, 1
    s_bitcmp1_b32 s11, s1
    s_nop 1
    v_pk_mul_f32 v[34:35], v[24:25], s[82:83] op_sel_hi:[1,0]
    v_pk_mul_f32 v[36:37], v[26:27], s[82:83] op_sel_hi:[1,0]
    v_readlane_b32 s84, v12, s81
    v_cvt_pk_bf16_f32 v32, v34, v35
    v_cvt_pk_bf16_f32 v33, v36, v37
    v_readlane_b32 s82, v13, s81
    ds_write_b64 v30, v[32:33]
    v_mov_b64 v[24:25], 0
    v_mov_b64 v[26:27], 0
    s_cbranch_scc0 L_f8
    s_call_b64 s[30:31], L_fl_x
    s_branch L_f8
L_fs8:
    s_nop 1
    v_xor_b32 v30, s84, v29
    s_add_u32 s1, s1, 1
    s_add_u32 s81, s81, 1
    s_bitcmp1_b32 s11, s1
    s_nop 1
    v_pk_mul_f32 v[34:35], v[24:25], s[82:83] op_sel_hi:[1,0]
    v_pk_mul_f32 v[36:37], v[26:27], s[82:83] op_sel_hi:[1,0]
    v_readlane_b32 s84, v12, s81
    v_cvt_pk_bf16_f32 v32, v34, v35
    v_cvt_pk_bf16_f32 v33, v36, v37
    v_readlane_b32 s82, v13, s81
    ds_write_b64 v30, v[32:33]
    v_mov_b64 v[24:25], 0
    v_mov_b64 v[26:27], 0
    s_cbranch_scc0 L_f9
    s_call_b64 s[30:31], L_fl_x
    s_branch L_f9
L_fs9:
    s_nop 1
    v_xor_b32 v30, s84, v29
    s_add_u32 s1, s1, 1
    s_add_u32 s81, s81, 1
    s_bitcmp1_b32 s11, s1
    s_nop 1
    v_pk_mul_f32 v[34:35], v[24:25], s[82:83] op_sel_hi:[1,0]
    v_pk_mul_f32 v[36:37], v[26:27], s[82:83] op_sel_hi:[1,0]
    v_readlane_b32 s84, v12, s81
    v_cvt_pk_bf16_f32 v32, v34, v35
    v_cvt_pk_bf16_f32 v33, v36, v37
    v_readlane_b32 s82, v13, s81
    ds_write_b64 v30, v[32:33]
    v_mov_b64 v[24:25], 0
    v_mov_b64 v[26:27], 0
    s_cbranch_scc0 L_f10
    s_call_b64 s[30:31], L_fl_x
    s_branch L_f10
L_fs10:
    s_nop 1
    v_xor_b32 v30, s84, v29
    s_add_u32 s1, s1, 1
    s_add_u32 s81, s81, 1
    s_bitcmp1_b32 s11, s1
    s_nop 1
    v_pk_mul_f32 v[34:35], v[24:25], s[82:83] op_sel_hi:[1,0]
    v_pk_mul_f32 v[36:37], v[26:27], s[82:83] op_sel_hi:[1,0]
    v_readlane_b32 s84, v12, s81
    v_cvt_pk_bf16_f32 v32, v34, v35
    v_cvt_pk_bf16_f32 v33, v36, v37
    v_readlane_b32 s82, v13, s81
    ds_write_b64 v30, v[32:33]
    v_mov_b64 v[24:25], 0
    v_mov_b64 v[26:27], 0
    s_cbranch_scc0 L_f11
    s_call_b64 s[30:31], L_fl_x
    s_branch L_f11
L_flush:
    v_xor_b32 v30, s84, v29
    s_add_u32 s1, s1, 1
    s_add_u32 s81, s81, 1
    s_bitcmp1_b32 s11, s1
    s_nop 1
    v_pk_mul_f32 v[34:35], v[24:25], s[82:83] op_sel_hi:[1,0]
    v_pk_mul_f32 v[36:37], v[26:27], s[82:83] op_sel_hi:[1,0]
    v_readlane_b32 s84, v12, s81
    v_cvt_pk_bf16_f32 v32, v34, v35
    v_cvt_pk_bf16_f32 v33, v36, v37
    v_readlane_b32 s82, v13, s81
    ds_write_b64 v30, v[32:33]
    v_mov_b64 v[24:25], 0
    v_mov_b64 v[26:27], 0
    s_cbranch_scc1 L_fl_x
    s_setpc_b64 s[30:31]
L_fl_x:
    s_add_u32 s52, s1, 2
    s_and_b32 s52, s52, 12
    s_add_u32 s52, s52, 43016
    v_mov_b32 v30, s52
    s_waitcnt lgkmcnt(0)
    s_mov_b64 exec, 1
    ds_add_u32 v30, v0
    s_mov_b64 exec, -1
    s_setpc_b64 s[30:31]
L_slow:
    s_waitcnt vmcnt(0)
    s_mov_b64 exec, 1
    ds_add_u32 v1, v0 offset:43008
    s_mov_b64 exec, -1
    v_lshlrev_b32 v2, 3, v1
    v_lshrrev_b32 v3, 1, v1
    v_lshlrev_b32 v3, 4, v3
    v_and_b32 v4, 1, v1
    v_lshl_or_b32 v29, v4, 3, v3
    s_mov_b32 s79, 61440
L_sl_node:
    v_readlane_b32 s77, v14, s81
    s_lshr_b32 s77, s77, 2
    s_mul_i32 s52, s2, 40
    s_add_u32 s77, s77, s52
    s_mov_b32 s78, 0
L_sl_chunk:
    v_lshl_add_u32 v3, v1, 2, s78
    global_load_dword v4, v3, s[8:9]
    global_load_dword v5, v3, s[6:7]
    s_waitcnt vmcnt(0)
    v_cmp_eq_u32 vcc, s77, v4
L_sl_edge:
    s_cmp_eq_u64 vcc, 0
    s_cbranch_scc1 L_sl_next
    s_ff1_i32_b64 s52, vcc
    s_bitset0_b64 vcc, s52
    v_readlane_b32 s53, v5, s52
    s_lshl_b32 s54, s53, 1
    s_lshl_b32 s55, s53, 9
    v_mov_b32 v6, s54
    buffer_load_ushort v7, v6, s[36:39], s79 offen
    buffer_load_dwordx2 v[60:61], v2, s[32:35], s55 offen
    s_waitcnt vmcnt(0)
    v_lshlrev_b32 v7, 16, v7
    v_lshlrev_b32 v62, 16, v60
    v_and_b32 v63, 0xffff0000, v60
    v_lshlrev_b32 v64, 16, v61
    v_and_b32 v65, 0xffff0000, v61
    v_fmac_f32 v24, v7, v62
    v_fmac_f32 v25, v7, v63
    v_fmac_f32 v26, v7, v64
    v_fmac_f32 v27, v7, v65
    s_branch L_sl_edge
L_sl_next:
    s_add_u32 s78, s78, 256
    s_cmp_lt_u32 s78, 640000
    s_cbranch_scc1 L_sl_chunk
    s_call_b64 s[30:31], L_flush
    s_cmp_lt_u32 s1, 10
    s_cbranch_scc1 L_sl_node
L_Bdone:
L_fin:
L_end:
    s_endpgm
L_giveup:
    v_lshlrev_b32 v12, 2, v1
    v_bfrev_b32 v13, 2
    s_mov_b64 exec, 0xffffff
    ds_write_b32 v12, v13 offset:43008
    s_waitcnt lgkmcnt(0)
    s_endpgm
L_code_end:
.section .rodata,"a"
.p2align 6
.amdhsa_kernel gather_scatter__hybrid_graph_tf_exphormer__graph_kernel
  .amdhsa_next_free_vgpr 256
  .amdhsa_next_free_sgpr 102
  .amdhsa_accum_offset 256
  .amdhsa_group_segment_fixed_size 0
  .amdhsa_kernarg_size 104
  .amdhsa_user_sgpr_count 2
  .amdhsa_user_sgpr_kernarg_segment_ptr 1
  .amdhsa_system_sgpr_workgroup_id_x 1
  .amdhsa_float_denorm_mode_32 3
.end_amdhsa_kernel
```
